```python
import torch

def _softmax(x, axis=-1):
    return torch.softmax(x, dim=axis)
def _gelu(x):
    return torch.nn.functional.gelu(x, approximate="tanh")
def _silu(x):
    return torch.nn.functional.silu(x)
def _sigmoid(x):
    return torch.sigmoid(x)
def _layernorm(x, axis=-1, eps=1e-5):
    m = x.mean(dim=axis, keepdim=True)
    v = x.var(dim=axis, keepdim=True, unbiased=False)
    return (x - m) / torch.sqrt(v + eps)
def _scatter_add(tgt, idx, src, axis=0):
    return tgt.clone().index_add_(axis, idx, src)
def _segment_sum(src, seg, n):
    out = torch.zeros((n,) + src.shape[1:], dtype=src.dtype)
    return out.index_add_(0, seg, src)
def _pad(x, pw):
    flat = tuple(v for pair in reversed(pw) for v in pair)
    return torch.nn.functional.pad(x, flat)

kernel_name = 'standalone__ssm_conv_s4__prompt'

def setup_inputs():

    _w = (lambda a: (lambda t: t.to(torch.bfloat16) if t.is_floating_point() else t)(torch.as_tensor(a)))
    B, L, D, N = 1, 2048, 1024, 128
    A_re = -(lambda _x: torch.exp(torch.as_tensor(_x)))((lambda *s: torch.randn(*s, dtype=torch.bfloat16) * 3.2)(D, N))
    A_im = torch.pi * (lambda *s: torch.randn(*s, dtype=torch.bfloat16) * 0.05)(D, N)
    B_re = (lambda *s: torch.randn(*s, dtype=torch.bfloat16) * 0.1)(D, N)
    B_im = (lambda *s: torch.randn(*s, dtype=torch.bfloat16) * 0.1)(D, N)
    C_re = (lambda *s: torch.randn(*s, dtype=torch.bfloat16) * 0.1)(D, N)
    C_im = (lambda *s: torch.randn(*s, dtype=torch.bfloat16) * 0.1)(D, N)
    log_dt = (lambda *s: torch.randn(*s, dtype=torch.bfloat16) * 0.05)(D) * 0.5 - 4.0
    Dskip = (lambda *s: torch.randn(*s, dtype=torch.bfloat16) * 0.05)(D)
    return {
        "u": _w((lambda *s: torch.randn(*s, dtype=torch.bfloat16) * 0.05)(B, L, D)),
        "A_re": _w(A_re),
        "A_im": _w(A_im),
        "B_re": _w(B_re),
        "B_im": _w(B_im),
        "C_re": _w(C_re),
        "C_im": _w(C_im),
        "log_dt": _w(log_dt),
        "Dskip": _w(Dskip),
    }

def reference(u, A_re, A_im, B_re, B_im, C_re, C_im, log_dt, Dskip):
    Bsz, L, D = u.shape
    dt = torch.exp(log_dt)[:, None]
    A = A_re + 1j * A_im
    Bc = B_re + 1j * B_im
    Cc = C_re + 1j * C_im
    logdA = dt * A
    dB = dt * Bc
    l = (lambda x, dt: x.to(dt))(torch.arange(L), A_re.dtype)
    P = torch.exp(logdA[:, :, None] * l[None, None, :])
    K = torch.einsum("dn,dnl,dn->dl", Cc, P, dB).real
    L2 = 2 * L
    Kp = _pad(K, ((0, 0), (0, L)))
    up = (lambda x, *d: x.permute(*d))(u, 0, 2, 1)
    up = _pad(up, ((0, 0), (0, 0), (0, L)))
    Kf = (lambda x, axes=(-2,-1): torch.fft.rfft2(x.float(), dim=axes))(Kp[:, None, :], axes=(-2, -1))
    Uf = (lambda x, axes=(-2,-1): torch.fft.rfft2(x.float(), dim=axes))(up[:, :, None, :], axes=(-2, -1))
    Yf = Uf * Kf[None, :, :, :]
    y = (lambda x, s, axes=(-2,-1): torch.fft.irfft2(x, s=s, dim=axes).to(torch.bfloat16))(Yf, (1, L2), axes=(-2, -1))[:, :, 0, :L]
    y = (lambda x, *d: x.permute(*d))(y, 0, 2, 1) + u * Dskip[None, None, :]
    return y
```

```asm
; @launch grid=(256,1,1) block=(512,1,1) lds=163840
.amdgcn_target "amdgcn-amd-amdhsa--gfx950"
.text
.globl standalone__ssm_conv_s4__prompt_kernel
.p2align 8
.type standalone__ssm_conv_s4__prompt_kernel,@function
standalone__ssm_conv_s4__prompt_kernel:
    s_load_dwordx16 s[4:19], s[0:1], 0
    s_load_dwordx4 s[20:23], s[0:1], 64
    s_cmp_ge_u32 s2, 256
    s_cbranch_scc1 L_end
    s_getpc_b64 s[38:39]
L_pc:
    v_readfirstlane_b32 s32, v0
    v_lshlrev_b32 v232, 4, v0
    s_add_u32 s40, s38, L_tbl-L_pc
    s_addc_u32 s41, s39, 0
    s_mul_i32 s37, s32, 65
    s_add_u32 m0, s37, 131648
    s_cmp_lg_u32 s32, 448
    s_cbranch_scc1 L_notb
    global_load_lds_dwordx4 v232, s[40:41] offset:1024
L_notb:
    s_cmp_lg_u32 s32, 0
    s_cbranch_scc1 L_nopf
    s_lshl_b32 s42, s2, 4
    v_and_b32 v233, 3, v0
    s_and_b32 s42, s42, 0xf80
    v_lshl_add_u32 v233, v233, 12, s42
    global_load_dword v248, v233, s[38:39]
L_nopf:
    global_load_lds_dwordx4 v232, s[40:41]
    s_lshr_b32 s32, s32, 6
    s_lshl_b32 s40, s2, 2
    s_lshr_b32 s40, 1698829168, s40
    s_and_b32 s40, s40, 7
    s_lshr_b32 s43, s2, 7
    s_lshl3_add_u32 s40, s43, s40
    s_bfe_u32 s42, s2, 0x20003
    s_bfe_u32 s43, s2, 0x10006
    s_lshl2_add_u32 s42, s43, s42
    s_lshl3_add_u32 s40, s40, s42
    s_lshl_b32 s34, s40, 4
    s_lshl_b32 s43, s40, 11
    s_lshl1_add_u32 s40, s32, s34
    v_and_b32 v1, 63, v0
    s_lshl_b32 s43, s40, 7
    v_lshl_add_u32 v233, v1, 1, s43
    v_mov_b32 v234, s40
    v_mov_b32 v78, 0
    s_bfe_u32 s33, s2, 0x10005
    v_and_b32 v1, 63, v0
    s_add_u32 s44, s42, s32
    v_bfe_u32 v236, v0, 5, 1
    s_and_b32 s44, s44, 7
    v_xor_b32 v236, s33, v236
    s_and_b32 s46, s44, 3
    v_and_or_b32 v236, v0, 6, v236
    s_cmp_ge_u32 s32, 4
    v_and_b32 v237, 56, v0
    s_cselect_b32 s46, 32, s46
    v_lshl_or_b32 v236, v237, 1, v236
    s_add_u32 s40, s42, 8
    v_and_b32 v237, 1, v0
    s_cmp_eq_u32 s32, 4
    v_mad_i32_i24 v236, v237, -8, v236
    s_cselect_b32 s46, s40, s46
    v_xor_b32 v237, 1, v236
    s_cmp_eq_u32 s33, 0
    v_lshl_add_u32 v235, v1, 11, v234
    s_cselect_b32 s46, s46, s44
    v_add_u32 v235, 4184064, v235
    s_lshl_b32 s40, s46, 18
    v_mov_b32 v19, 0
    s_add_u32 s40, s40, 6144
    s_mov_b32 s27, 0x00020000
    s_mov_b32 s26, 4194304
    v_lshl_add_u32 v236, v236, 11, s40
    v_lshl_add_u32 v237, v237, 11, s40
    s_add_u32 s37, s37, 130560
    v_mov_b32 v10, 0
    s_mov_b32 m0, s37
    v_mov_b32 v232, 0x3c00
    s_mul_i32 s35, s32, 16320
    v_lshlrev_b32 v15, 4, v1
    v_add_u32 v15, 131648, v15
    ds_write_addtid_b32 v10 offset:544
    ds_write_addtid_b32 v10 offset:800
    s_mov_b32 m0, s35
    s_lshl_b32 s41, s33, 4
    ds_write_addtid_b32 v10 offset:16
    ds_write_addtid_b32 v232 offset:0
    ds_write_addtid_b32 v10 offset:14688
    ds_write_addtid_b32 v10 offset:14944
    ds_write_addtid_b32 v10 offset:15328
    v_mov_b64 v[86:87], 0
    v_mov_b64 v[90:91], 0
    v_mov_b64 v[92:93], 0
    v_mov_b64 v[72:73], 0
    v_mov_b64 v[74:75], 0
    v_mov_b64 v[76:77], 0
    s_waitcnt lgkmcnt(0)
    global_load_short_d16_hi v78, v234, s[18:19]
    global_load_short_d16_hi v86, v233, s[6:7]
    global_load_short_d16_hi v87, v233, s[8:9]
    s_mov_b64 s[24:25], s[4:5]
    s_barrier
    global_load_short_d16_hi v90, v233, s[10:11]
    global_load_short_d16_hi v74, v233, s[10:11] offset:128
    global_load_short_d16_hi v91, v233, s[12:13]
    global_load_short_d16_hi v75, v233, s[12:13] offset:128
    global_load_short_d16_hi v92, v233, s[14:15]
    global_load_short_d16_hi v76, v233, s[14:15] offset:128
    global_load_short_d16_hi v93, v233, s[16:17]
    global_load_short_d16_hi v77, v233, s[16:17] offset:128
    global_load_short_d16_hi v72, v233, s[6:7] offset:128
    global_load_short_d16_hi v73, v233, s[8:9] offset:128
    global_load_short_d16_hi v19, v234, s[20:21]
    buffer_load_ushort v24, v235, s[24:27], 0 offen
    s_mov_b32 s51, 0xffff0000
    s_cmp_eq_u32 s33, 0
    s_cselect_b32 s40, 4, 8
    s_cselect_b32 s57, 2621440, s26
    s_add_u32 s40, s40, s44
    s_sub_u32 s40, s40, s46
    s_lshl_b32 s47, s40, 18
    s_add_u32 s36, s46, 4
    s_cmp_ge_u32 s32, 4
    s_cselect_b32 s36, 0, s36
    s_cmp_eq_u32 s33, 0
    s_cselect_b32 s36, s36, s44
    s_mov_b32 s48, 0x01000504
    s_cselect_b32 s48, 0x05040100, s48
    s_lshl_b32 s36, s36, 8
    s_lshl_b32 s50, s44, 8
    s_add_u32 s36, s36, 130592
    s_add_u32 s50, s50, 132640
    s_mov_b32 s30, 4194304
    s_mov_b32 s31, 0x00020000
    s_mov_b64 s[52:53], 1
    s_lshl_b32 s58, s32, 6
    s_and_b32 s43, s32, 3
    s_lshr_b32 s45, s32, 2
    s_lshl1_add_u32 s43, s43, s45
    s_lshl_b32 s43, s43, 1
    s_mov_b64 s[28:29], s[22:23]
    s_cmp_gt_u32 s32, 1
    s_cbranch_scc1 L_nopad
    s_mov_b64 exec, 0
    s_cmp_eq_u32 s32, 0
    s_cbranch_scc1 L_main1
    s_cmp_eq_u32 s33, 0
    s_cbranch_scc1 L_role0
    s_branch L_role1
L_back0:
L_back1:
    s_mov_b64 exec, -1
L_nopad:
    s_waitcnt vmcnt(15)
    s_barrier
    buffer_load_dwordx4 v[56:59], v236, s[24:27], s34 offen
    buffer_load_dwordx4 v[60:63], v237, s[24:27], s34 offen
    ds_read_b128 v[224:227], v15 offset:29120
    ds_read_b128 v[228:231], v15 offset:30144
    ds_read_b128 v[28:31], v15 offset:0
    ds_read_b128 v[32:35], v15 offset:4160
    ds_read_b128 v[36:39], v15 offset:8320
    ds_read_b128 v[40:43], v15 offset:12480
    ds_read_b128 v[44:47], v15 offset:16640
    ds_read_b128 v[48:51], v15 offset:20800
    ds_read_b128 v[52:55], v15 offset:24960
    s_mov_b32 s26, s57
    v_add_u32 v12, s47, v236
    v_add_u32 v13, s47, v237
    s_waitcnt lgkmcnt(8)
    v_lshrrev_b32 v224, s41, v224
    v_add_u32_sdwa v18, s35, v224 dst_sel:DWORD dst_unused:UNUSED_PAD src0_sel:DWORD src1_sel:WORD_0
    v_add_u32_sdwa v17, s35, v225 dst_sel:DWORD dst_unused:UNUSED_PAD src0_sel:DWORD src1_sel:WORD_0
    v_add_u32_sdwa v14, s37, v225 dst_sel:DWORD dst_unused:UNUSED_PAD src0_sel:DWORD src1_sel:WORD_1
    s_waitcnt vmcnt(16)
    v_mul_f32 v84, 0x3fb8aa3b, v78
    v_exp_f32 v84, v84
    s_nop 0
    v_cvt_pk_bf16_f32 v84, 0, v84
    v_mul_f32 v80, 0x3fb8aa3b, v84
    v_mul_f32 v81, 0.15915494, v84
    s_waitcnt vmcnt(14)
    v_pk_mul_f32 v[86:87], v[86:87], v[80:81]
    v_rndne_f32 v88, v87
    v_exp_f32 v86, v86
    v_sub_f32 v87, v87, v88
    v_cos_f32 v88, v87
    v_sin_f32 v89, v87
    s_nop 0
    v_pk_mul_f32 v[88:89], v[88:89], v[86:87] op_sel_hi:[1,0]
    v_cvt_pk_f16_f32 v102, v88, v89
    v_pk_mul_f32 v[98:99], v[88:89], v[88:89] op_sel_hi:[1,0]
    v_pk_fma_f32 v[88:89], v[88:89], v[88:89], v[98:99] op_sel:[1,1,0] op_sel_hi:[0,1,1] neg_lo:[1,0,0]
    v_cvt_pk_f16_f32 v103, v88, v89
    v_pk_mul_f32 v[100:101], v[88:89], v[88:89] op_sel_hi:[1,0]
    v_pk_fma_f32 v[88:89], v[88:89], v[88:89], v[100:101] op_sel:[1,1,0] op_sel_hi:[0,1,1] neg_lo:[1,0,0]
    v_cvt_pk_f16_f32 v104, v88, v89
    v_pk_mul_f32 v[98:99], v[88:89], v[88:89] op_sel_hi:[1,0]
    v_pk_fma_f32 v[88:89], v[88:89], v[88:89], v[98:99] op_sel:[1,1,0] op_sel_hi:[0,1,1] neg_lo:[1,0,0]
    v_cvt_pk_f16_f32 v108, v88, v89
    v_pk_mul_f32 v[100:101], v[88:89], v[88:89] op_sel_hi:[1,0]
    v_pk_fma_f32 v[88:89], v[88:89], v[88:89], v[100:101] op_sel:[1,1,0] op_sel_hi:[0,1,1] neg_lo:[1,0,0]
    v_cvt_pk_f16_f32 v109, v88, v89
    s_barrier
.p2align 3
    v_pk_mul_f16 v133, v108, v109 op_sel_hi:[1,0]
    v_pk_fma_f16 v110, v108, v109, v133 op_sel:[1,1,0] op_sel_hi:[0,1,1] neg_lo:[1,0,0]
    v_pk_mul_f32 v[100:101], v[88:89], v[88:89] op_sel_hi:[1,0]
    v_pk_fma_f32 v[88:89], v[88:89], v[88:89], v[100:101] op_sel:[1,1,0] op_sel_hi:[0,1,1] neg_lo:[1,0,0]
    ds_write_addtid_b32 v108 offset:272
    ds_write_addtid_b32 v109 offset:544
    v_cvt_pk_f16_f32 v111, v88, v89
    v_pk_mul_f16 v133, v108, v111 op_sel_hi:[1,0]
    v_pk_fma_f16 v112, v108, v111, v133 op_sel:[1,1,0] op_sel_hi:[0,1,1] neg_lo:[1,0,0]
    v_pk_mul_f32 v[100:101], v[88:89], v[88:89] op_sel_hi:[1,0]
    ds_write_addtid_b32 v110 offset:816
    ds_write_addtid_b32 v111 offset:1088
    v_pk_fma_f32 v[88:89], v[88:89], v[88:89], v[100:101] op_sel:[1,1,0] op_sel_hi:[0,1,1] neg_lo:[1,0,0]
    v_cvt_pk_f16_f32 v115, v88, v89
    v_pk_mul_f16 v133, v109, v111 op_sel_hi:[1,0]
    v_pk_fma_f16 v113, v109, v111, v133 op_sel:[1,1,0] op_sel_hi:[0,1,1] neg_lo:[1,0,0]
    ds_write_addtid_b32 v112 offset:1360
    ds_write_addtid_b32 v115 offset:2176
    v_pk_mul_f16 v134, v110, v111 op_sel_hi:[1,0]
    v_pk_fma_f16 v114, v110, v111, v134 op_sel:[1,1,0] op_sel_hi:[0,1,1] neg_lo:[1,0,0]
    v_pk_mul_f16 v133, v108, v115 op_sel_hi:[1,0]
    v_pk_fma_f16 v116, v108, v115, v133 op_sel:[1,1,0] op_sel_hi:[0,1,1] neg_lo:[1,0,0]
    ds_write_addtid_b32 v113 offset:1632
    ds_write_addtid_b32 v114 offset:1904
    v_pk_mul_f32 v[100:101], v[88:89], v[88:89] op_sel_hi:[1,0]
    v_pk_fma_f32 v[88:89], v[88:89], v[88:89], v[100:101] op_sel:[1,1,0] op_sel_hi:[0,1,1] neg_lo:[1,0,0]
    v_cvt_pk_f16_f32 v123, v88, v89
    v_pk_mul_f16 v133, v109, v115 op_sel_hi:[1,0]
    ds_write_addtid_b32 v116 offset:2448
    ds_write_addtid_b32 v123 offset:4352
    v_pk_fma_f16 v117, v109, v115, v133 op_sel:[1,1,0] op_sel_hi:[0,1,1] neg_lo:[1,0,0]
    v_pk_mul_f16 v134, v110, v115 op_sel_hi:[1,0]
    v_pk_fma_f16 v118, v110, v115, v134 op_sel:[1,1,0] op_sel_hi:[0,1,1] neg_lo:[1,0,0]
    v_pk_mul_f16 v133, v111, v115 op_sel_hi:[1,0]
    ds_write_addtid_b32 v117 offset:2720
    ds_write_addtid_b32 v118 offset:2992
    v_pk_fma_f16 v119, v111, v115, v133 op_sel:[1,1,0] op_sel_hi:[0,1,1] neg_lo:[1,0,0]
    v_pk_mul_f16 v134, v112, v115 op_sel_hi:[1,0]
    v_pk_fma_f16 v120, v112, v115, v134 op_sel:[1,1,0] op_sel_hi:[0,1,1] neg_lo:[1,0,0]
    v_pk_mul_f16 v133, v113, v115 op_sel_hi:[1,0]
    ds_write_addtid_b32 v119 offset:3264
    ds_write_addtid_b32 v120 offset:3536
    v_pk_fma_f16 v121, v113, v115, v133 op_sel:[1,1,0] op_sel_hi:[0,1,1] neg_lo:[1,0,0]
    v_pk_mul_f16 v134, v114, v115 op_sel_hi:[1,0]
    v_pk_fma_f16 v122, v114, v115, v134 op_sel:[1,1,0] op_sel_hi:[0,1,1] neg_lo:[1,0,0]
    v_pk_mul_f16 v133, v108, v123 op_sel_hi:[1,0]
    ds_write_addtid_b32 v121 offset:3808
    ds_write_addtid_b32 v122 offset:4080
    v_pk_fma_f16 v136, v108, v123, v133 op_sel:[1,1,0] op_sel_hi:[0,1,1] neg_lo:[1,0,0]
    v_pk_mul_f16 v134, v109, v123 op_sel_hi:[1,0]
    v_pk_fma_f16 v137, v109, v123, v134 op_sel:[1,1,0] op_sel_hi:[0,1,1] neg_lo:[1,0,0]
    v_pk_mul_f16 v133, v110, v123 op_sel_hi:[1,0]
    ds_write_addtid_b32 v136 offset:4624
    ds_write_addtid_b32 v137 offset:4896
    v_pk_fma_f16 v138, v110, v123, v133 op_sel:[1,1,0] op_sel_hi:[0,1,1] neg_lo:[1,0,0]
    v_pk_mul_f16 v134, v111, v123 op_sel_hi:[1,0]
    v_pk_fma_f16 v139, v111, v123, v134 op_sel:[1,1,0] op_sel_hi:[0,1,1] neg_lo:[1,0,0]
    v_pk_mul_f16 v133, v112, v123 op_sel_hi:[1,0]
    ds_write_addtid_b32 v138 offset:5168
    ds_write_addtid_b32 v139 offset:5440
    v_pk_fma_f16 v140, v112, v123, v133 op_sel:[1,1,0] op_sel_hi:[0,1,1] neg_lo:[1,0,0]
    v_pk_mul_f16 v134, v113, v123 op_sel_hi:[1,0]
    v_pk_fma_f16 v141, v113, v123, v134 op_sel:[1,1,0] op_sel_hi:[0,1,1] neg_lo:[1,0,0]
    v_pk_mul_f16 v133, v114, v123 op_sel_hi:[1,0]
    ds_write_addtid_b32 v140 offset:5712
    ds_write_addtid_b32 v141 offset:5984
    v_pk_fma_f16 v142, v114, v123, v133 op_sel:[1,1,0] op_sel_hi:[0,1,1] neg_lo:[1,0,0]
    v_pk_mul_f16 v134, v115, v123 op_sel_hi:[1,0]
    v_pk_fma_f16 v135, v115, v123, v134 op_sel:[1,1,0] op_sel_hi:[0,1,1] neg_lo:[1,0,0]
    v_pk_mul_f16 v133, v116, v123 op_sel_hi:[1,0]
    ds_write_addtid_b32 v142 offset:6256
    ds_write_addtid_b32 v135 offset:6528
    v_pk_fma_f16 v136, v116, v123, v133 op_sel:[1,1,0] op_sel_hi:[0,1,1] neg_lo:[1,0,0]
    v_pk_mul_f16 v134, v117, v123 op_sel_hi:[1,0]
    v_pk_fma_f16 v137, v117, v123, v134 op_sel:[1,1,0] op_sel_hi:[0,1,1] neg_lo:[1,0,0]
    v_pk_mul_f16 v133, v118, v123 op_sel_hi:[1,0]
    ds_write_addtid_b32 v136 offset:6800
    ds_write_addtid_b32 v137 offset:7072
    v_pk_fma_f16 v138, v118, v123, v133 op_sel:[1,1,0] op_sel_hi:[0,1,1] neg_lo:[1,0,0]
    v_pk_mul_f16 v134, v119, v123 op_sel_hi:[1,0]
    v_pk_fma_f16 v139, v119, v123, v134 op_sel:[1,1,0] op_sel_hi:[0,1,1] neg_lo:[1,0,0]
    v_pk_mul_f16 v133, v120, v123 op_sel_hi:[1,0]
    ds_write_addtid_b32 v138 offset:7344
    ds_write_addtid_b32 v139 offset:7616
    v_pk_fma_f16 v140, v120, v123, v133 op_sel:[1,1,0] op_sel_hi:[0,1,1] neg_lo:[1,0,0]
    v_pk_mul_f16 v134, v121, v123 op_sel_hi:[1,0]
    v_pk_fma_f16 v141, v121, v123, v134 op_sel:[1,1,0] op_sel_hi:[0,1,1] neg_lo:[1,0,0]
    v_pk_mul_f16 v133, v122, v123 op_sel_hi:[1,0]
    ds_write_addtid_b32 v140 offset:7888
    ds_write_addtid_b32 v141 offset:8160
    v_pk_fma_f16 v142, v122, v123, v133 op_sel:[1,1,0] op_sel_hi:[0,1,1] neg_lo:[1,0,0]
    ds_write_addtid_b32 v142 offset:8432
    s_cmp_lt_u32 s32, 4
    s_cbranch_scc1 L_yp
    s_setprio 1
L_yp:
    s_waitcnt vmcnt(11)
    v_pk_mul_f32 v[90:91], v[90:91], v[84:85] op_sel_hi:[1,0]
    s_waitcnt vmcnt(7)
    v_pk_mul_f32 v[98:99], v[92:93], v[90:91] op_sel_hi:[1,0]
    v_pk_fma_f32 v[94:95], v[92:93], v[90:91], v[98:99] op_sel:[1,1,0] op_sel_hi:[0,1,1] neg_lo:[1,0,0]
    v_pk_mul_f32 v[74:75], v[74:75], v[84:85] op_sel_hi:[1,0]
    s_waitcnt vmcnt(6)
    v_pk_mul_f32 v[100:101], v[76:77], v[74:75] op_sel_hi:[1,0]
    v_pk_fma_f32 v[96:97], v[76:77], v[74:75], v[100:101] op_sel:[1,1,0] op_sel_hi:[0,1,1] neg_lo:[1,0,0]
    v_max3_f32 v86, abs(v94), abs(v95), abs(v96)
    v_max_f32_e64 v86, v86, abs(v97)
    v_pk_mul_f32 v[98:99], v[88:89], v[88:89] op_sel_hi:[1,0]
    v_pk_fma_f32 v[88:89], v[88:89], v[88:89], v[98:99] op_sel:[1,1,0] op_sel_hi:[0,1,1] neg_lo:[1,0,0]
    v_max_f32_dpp v86, v86, v86 row_shr:1 row_mask:0xf bank_mask:0xf
    v_cvt_pk_f16_f32 v105, v88, v89
    v_pk_mul_f32 v[100:101], v[88:89], v[88:89] op_sel_hi:[1,0]
    v_max_f32_dpp v86, v86, v86 row_shr:2 row_mask:0xf bank_mask:0xf
    v_pk_fma_f32 v[88:89], v[88:89], v[88:89], v[100:101] op_sel:[1,1,0] op_sel_hi:[0,1,1] neg_lo:[1,0,0]
    v_cvt_pk_f16_f32 v106, v88, v89
    v_max_f32_dpp v86, v86, v86 row_shr:4 row_mask:0xf bank_mask:0xf
    v_pk_mul_f32 v[98:99], v[88:89], v[88:89] op_sel_hi:[1,0]
    v_pk_fma_f32 v[88:89], v[88:89], v[88:89], v[98:99] op_sel:[1,1,0] op_sel_hi:[0,1,1] neg_lo:[1,0,0]
    v_max_f32_dpp v86, v86, v86 row_shr:8 row_mask:0xf bank_mask:0xf
    v_cvt_pk_f16_f32 v107, v88, v89
    s_nop 0
    v_max_f32_dpp v86, v86, v86 row_bcast:15 row_mask:0xa bank_mask:0xf
    s_nop 1
    v_max_f32_dpp v86, v86, v86 row_bcast:31 row_mask:0xc bank_mask:0xf
    s_nop 0
    v_readlane_b32 s55, v86, 63
    s_waitcnt vmcnt(2)
    ds_write_b16 v14, v24
    s_and_b32 s55, s55, 0x7f800000
    s_max_u32 s55, s55, 335544320
    s_min_u32 s55, s55, 2130706432
    s_sub_u32 s55, s55, 67108864
    s_sub_u32 s54, 2130706432, s55
.p2align 3
    s_setprio 0
.p2align 3
    v_pk_mul_f32 v[94:95], v[94:95], s[54:55] op_sel_hi:[1,0]
    v_cvt_pk_f16_f32 v124, v94, -v95
    v_pk_mul_f16 v134, v124, v102 op_sel_hi:[1,0]
    v_pk_fma_f16 v125, v124, v102, v134 op_sel:[1,1,0] op_sel_hi:[0,1,1] neg_hi:[1,0,0]
    ds_write_addtid_b32 v124 offset:12784
    ds_write_addtid_b32 v125 offset:10064
    v_pk_mul_f16 v133, v124, v103 op_sel_hi:[1,0]
    v_pk_fma_f16 v126, v124, v103, v133 op_sel:[1,1,0] op_sel_hi:[0,1,1] neg_hi:[1,0,0]
    v_pk_mul_f16 v134, v125, v103 op_sel_hi:[1,0]
    v_pk_fma_f16 v127, v125, v103, v134 op_sel:[1,1,0] op_sel_hi:[0,1,1] neg_hi:[1,0,0]
    ds_write_addtid_b32 v126 offset:13872
    ds_write_addtid_b32 v127 offset:14144
    v_pk_mul_f16 v133, v124, v104 op_sel_hi:[1,0]
    v_pk_fma_f16 v128, v124, v104, v133 op_sel:[1,1,0] op_sel_hi:[0,1,1] neg_hi:[1,0,0]
    v_pk_mul_f16 v134, v125, v104 op_sel_hi:[1,0]
    v_pk_fma_f16 v135, v125, v104, v134 op_sel:[1,1,0] op_sel_hi:[0,1,1] neg_hi:[1,0,0]
    ds_write_addtid_b32 v128 offset:9520
    ds_write_addtid_b32 v135 offset:9792
    v_pk_mul_f16 v133, v126, v104 op_sel_hi:[1,0]
    v_pk_fma_f16 v129, v126, v104, v133 op_sel:[1,1,0] op_sel_hi:[0,1,1] neg_hi:[1,0,0]
    v_pk_mul_f16 v134, v127, v104 op_sel_hi:[1,0]
    v_pk_fma_f16 v136, v127, v104, v134 op_sel:[1,1,0] op_sel_hi:[0,1,1] neg_hi:[1,0,0]
    ds_write_addtid_b32 v129 offset:11152
    ds_write_addtid_b32 v136 offset:10880
    v_pk_mul_f16 v133, v124, v108 op_sel_hi:[1,0]
    v_pk_fma_f16 v130, v124, v108, v133 op_sel:[1,1,0] op_sel_hi:[0,1,1] neg_hi:[1,0,0]
    v_pk_mul_f16 v134, v124, v105 op_sel_hi:[1,0]
    v_pk_fma_f16 v137, v124, v105, v134 op_sel:[1,1,0] op_sel_hi:[0,1,1] neg_hi:[1,0,0]
    ds_write_addtid_b32 v130 offset:14416
    ds_write_addtid_b32 v137 offset:11968
    v_pk_mul_f16 v133, v126, v105 op_sel_hi:[1,0]
    v_pk_fma_f16 v138, v126, v105, v133 op_sel:[1,1,0] op_sel_hi:[0,1,1] neg_hi:[1,0,0]
    v_pk_mul_f16 v134, v128, v105 op_sel_hi:[1,0]
    v_pk_fma_f16 v139, v128, v105, v134 op_sel:[1,1,0] op_sel_hi:[0,1,1] neg_hi:[1,0,0]
    ds_write_addtid_b32 v138 offset:12512
    ds_write_addtid_b32 v139 offset:11696
    v_pk_mul_f16 v133, v129, v105 op_sel_hi:[1,0]
    v_pk_fma_f16 v140, v129, v105, v133 op_sel:[1,1,0] op_sel_hi:[0,1,1] neg_hi:[1,0,0]
    v_pk_mul_f16 v134, v130, v105 op_sel_hi:[1,0]
    v_pk_fma_f16 v141, v130, v105, v134 op_sel:[1,1,0] op_sel_hi:[0,1,1] neg_hi:[1,0,0]
    ds_write_addtid_b32 v140 offset:10608
    ds_write_addtid_b32 v141 offset:9248
    v_pk_mul_f16 v133, v128, v106 op_sel_hi:[1,0]
    v_pk_fma_f16 v131, v128, v106, v133 op_sel:[1,1,0] op_sel_hi:[0,1,1] neg_hi:[1,0,0]
    v_pk_mul_f16 v134, v130, v106 op_sel_hi:[1,0]
    v_pk_fma_f16 v132, v130, v106, v134 op_sel:[1,1,0] op_sel_hi:[0,1,1] neg_hi:[1,0,0]
    ds_write_addtid_b32 v131 offset:12240
    ds_write_addtid_b32 v132 offset:13600
    v_pk_mul_f16 v133, v131, v105 op_sel_hi:[1,0]
    v_pk_fma_f16 v142, v131, v105, v133 op_sel:[1,1,0] op_sel_hi:[0,1,1] neg_hi:[1,0,0]
    v_pk_mul_f16 v134, v132, v105 op_sel_hi:[1,0]
    v_pk_fma_f16 v135, v132, v105, v134 op_sel:[1,1,0] op_sel_hi:[0,1,1] neg_hi:[1,0,0]
    ds_write_addtid_b32 v142 offset:11424
    ds_write_addtid_b32 v135 offset:10336
    v_pk_mul_f16 v133, v130, v107 op_sel_hi:[1,0]
    v_pk_fma_f16 v125, v130, v107, v133 op_sel:[1,1,0] op_sel_hi:[0,1,1] neg_hi:[1,0,0]
    v_pk_mul_f16 v134, v125, v105 op_sel_hi:[1,0]
    v_pk_fma_f16 v136, v125, v105, v134 op_sel:[1,1,0] op_sel_hi:[0,1,1] neg_hi:[1,0,0]
    ds_write_addtid_b32 v125 offset:8976
    ds_write_addtid_b32 v136 offset:13328
    s_cmp_eq_u32 s33, 0
    s_cbranch_scc1 L_skip0
    v_pk_mul_f16 v133, v125, v106 op_sel_hi:[1,0]
    v_pk_fma_f16 v127, v125, v106, v133 op_sel:[1,1,0] op_sel_hi:[0,1,1] neg_hi:[1,0,0]
    v_pk_mul_f16 v134, v127, v105 op_sel_hi:[1,0]
    v_pk_fma_f16 v137, v127, v105, v134 op_sel:[1,1,0] op_sel_hi:[0,1,1] neg_hi:[1,0,0]
    ds_write_addtid_b32 v127 offset:8704
    ds_write_addtid_b32 v137 offset:13056
L_skip0:
    ds_read_b128 v[144:147], v18 offset:0
    ds_read_b128 v[148:151], v17 offset:0
    ds_read_b128 v[152:155], v18 offset:32
    ds_read_b128 v[156:159], v17 offset:32
    v_mul_f32 v86, v72, v80
    v_mul_f32 v87, v73, v81
    v_rndne_f32 v88, v87
    v_exp_f32 v86, v86
    s_waitcnt lgkmcnt(2)
    v_mfma_f32_32x32x16_f16 v[208:223], v[144:147], v[148:151], 0
    ds_read_b128 v[160:163], v18 offset:64
    ds_read_b128 v[164:167], v17 offset:64
    v_sub_f32 v87, v87, v88
    v_cos_f32 v88, v87
    v_sin_f32 v89, v87
    s_waitcnt lgkmcnt(2)
    v_mfma_f32_32x32x16_f16 v[208:223], v[152:155], v[156:159], v[208:223]
    ds_read_b128 v[168:171], v18 offset:96
    ds_read_b128 v[172:175], v17 offset:96
    v_mul_f32 v88, v88, v86
    v_mul_f32 v89, v89, v86
    v_cvt_pk_f16_f32 v102, v88, v89
    v_mul_f32 v100, v89, v89
    v_mul_f32_e64 v89, v88, v89 mul:2
    s_waitcnt lgkmcnt(2)
    v_mfma_f32_32x32x16_f16 v[208:223], v[160:163], v[164:167], v[208:223]
    ds_read_b128 v[176:179], v18 offset:128
    ds_read_b128 v[180:183], v17 offset:128
    v_fma_f32 v88, v88, v88, -v100
    v_cvt_pk_f16_f32 v103, v88, v89
    v_mul_f32 v98, v89, v89
    v_mul_f32_e64 v89, v88, v89 mul:2
    v_fma_f32 v88, v88, v88, -v98
    s_waitcnt lgkmcnt(2)
    v_mfma_f32_32x32x16_f16 v[208:223], v[168:171], v[172:175], v[208:223]
    ds_read_b128 v[184:187], v18 offset:160
    ds_read_b128 v[188:191], v17 offset:160
    v_cvt_pk_f16_f32 v104, v88, v89
    v_mul_f32 v100, v89, v89
    v_mul_f32_e64 v89, v88, v89 mul:2
    v_fma_f32 v88, v88, v88, -v100
    v_cvt_pk_f16_f32 v108, v88, v89
    s_waitcnt lgkmcnt(2)
    v_mfma_f32_32x32x16_f16 v[208:223], v[176:179], v[180:183], v[208:223]
    ds_read_b128 v[192:195], v18 offset:192
    ds_read_b128 v[196:199], v17 offset:192
    v_mul_f32 v98, v89, v89
    v_mul_f32_e64 v89, v88, v89 mul:2
    v_fma_f32 v88, v88, v88, -v98
    v_cvt_pk_f16_f32 v109, v88, v89
    v_mul_f32 v100, v89, v89
    s_waitcnt lgkmcnt(2)
    v_mfma_f32_32x32x16_f16 v[208:223], v[184:187], v[188:191], v[208:223]
    ds_read_b128 v[200:203], v18 offset:224
    ds_read_b128 v[204:207], v17 offset:224
    v_mul_f32_e64 v89, v88, v89 mul:2
    v_fma_f32 v88, v88, v88, -v100
    v_cvt_pk_f16_f32 v111, v88, v89
    v_mul_f32 v98, v89, v89
    v_mul_f32_e64 v89, v88, v89 mul:2
    s_waitcnt lgkmcnt(2)
    v_mfma_f32_32x32x16_f16 v[208:223], v[192:195], v[196:199], v[208:223]
    buffer_load_dwordx4 v[240:243], v12, s[24:27], s34 offen
    v_fma_f32 v88, v88, v88, -v98
    v_cvt_pk_f16_f32 v115, v88, v89
    s_waitcnt lgkmcnt(0)
    v_mfma_f32_32x32x16_f16 v[208:223], v[200:203], v[204:207], v[208:223]
    s_branch L_main1
.p2align 12
L_main1:
    s_cbranch_execz L_back0
    s_setprio 0
    s_barrier
.p2align 3
    v_pk_mul_f32 v[100:101], v[88:89], v[88:89] op_sel_hi:[1,0]
    v_pk_fma_f32 v[88:89], v[88:89], v[88:89], v[100:101] op_sel:[1,1,0] op_sel_hi:[0,1,1] neg_lo:[1,0,0]
    v_cvt_pk_f16_f32 v123, v88, v89
    v_pk_mul_f32 v[100:101], v[88:89], v[88:89] op_sel_hi:[1,0]
    ds_write_addtid_b32 v115 offset:2176
    ds_write_addtid_b32 v108 offset:272
    v_pk_fma_f32 v[88:89], v[88:89], v[88:89], v[100:101] op_sel:[1,1,0] op_sel_hi:[0,1,1] neg_lo:[1,0,0]
    v_cvt_pk_f16_f32 v105, v88, v89
    v_pk_mul_f32 v[98:99], v[88:89], v[88:89] op_sel_hi:[1,0]
    v_pk_fma_f32 v[88:89], v[88:89], v[88:89], v[98:99] op_sel:[1,1,0] op_sel_hi:[0,1,1] neg_lo:[1,0,0]
    ds_write_addtid_b32 v123 offset:4352
    ds_write_addtid_b32 v109 offset:544
    v_cvt_pk_f16_f32 v106, v88, v89
    v_pk_mul_f32 v[100:101], v[88:89], v[88:89] op_sel_hi:[1,0]
    v_pk_fma_f32 v[88:89], v[88:89], v[88:89], v[100:101] op_sel:[1,1,0] op_sel_hi:[0,1,1] neg_lo:[1,0,0]
    v_cvt_pk_f16_f32 v107, v88, v89
    v_pk_mul_f16 v133, v108, v109 op_sel_hi:[1,0]
    v_pk_fma_f16 v110, v108, v109, v133 op_sel:[1,1,0] op_sel_hi:[0,1,1] neg_lo:[1,0,0]
    v_pk_mul_f16 v134, v108, v111 op_sel_hi:[1,0]
    v_pk_fma_f16 v112, v108, v111, v134 op_sel:[1,1,0] op_sel_hi:[0,1,1] neg_lo:[1,0,0]
    ds_write_addtid_b32 v110 offset:816
    ds_write_addtid_b32 v111 offset:1088
    v_pk_mul_f16 v133, v109, v111 op_sel_hi:[1,0]
    v_pk_fma_f16 v113, v109, v111, v133 op_sel:[1,1,0] op_sel_hi:[0,1,1] neg_lo:[1,0,0]
    v_pk_mul_f16 v134, v110, v111 op_sel_hi:[1,0]
    v_pk_fma_f16 v114, v110, v111, v134 op_sel:[1,1,0] op_sel_hi:[0,1,1] neg_lo:[1,0,0]
    ds_write_addtid_b32 v112 offset:1360
    ds_write_addtid_b32 v113 offset:1632
    v_pk_mul_f16 v133, v108, v115 op_sel_hi:[1,0]
    v_pk_fma_f16 v116, v108, v115, v133 op_sel:[1,1,0] op_sel_hi:[0,1,1] neg_lo:[1,0,0]
    v_pk_mul_f16 v134, v109, v115 op_sel_hi:[1,0]
    v_pk_fma_f16 v117, v109, v115, v134 op_sel:[1,1,0] op_sel_hi:[0,1,1] neg_lo:[1,0,0]
    ds_write_addtid_b32 v114 offset:1904
    ds_write_addtid_b32 v116 offset:2448
    v_pk_mul_f16 v133, v110, v115 op_sel_hi:[1,0]
    v_pk_fma_f16 v118, v110, v115, v133 op_sel:[1,1,0] op_sel_hi:[0,1,1] neg_lo:[1,0,0]
    v_pk_mul_f16 v134, v111, v115 op_sel_hi:[1,0]
    v_pk_fma_f16 v119, v111, v115, v134 op_sel:[1,1,0] op_sel_hi:[0,1,1] neg_lo:[1,0,0]
    ds_write_addtid_b32 v117 offset:2720
    ds_write_addtid_b32 v118 offset:2992
    v_pk_mul_f16 v133, v112, v115 op_sel_hi:[1,0]
    v_pk_fma_f16 v120, v112, v115, v133 op_sel:[1,1,0] op_sel_hi:[0,1,1] neg_lo:[1,0,0]
    v_pk_mul_f16 v134, v113, v115 op_sel_hi:[1,0]
    v_pk_fma_f16 v121, v113, v115, v134 op_sel:[1,1,0] op_sel_hi:[0,1,1] neg_lo:[1,0,0]
    ds_write_addtid_b32 v119 offset:3264
    ds_write_addtid_b32 v120 offset:3536
    v_pk_mul_f16 v133, v114, v115 op_sel_hi:[1,0]
    v_pk_fma_f16 v122, v114, v115, v133 op_sel:[1,1,0] op_sel_hi:[0,1,1] neg_lo:[1,0,0]
    v_pk_mul_f16 v134, v108, v123 op_sel_hi:[1,0]
    v_pk_fma_f16 v136, v108, v123, v134 op_sel:[1,1,0] op_sel_hi:[0,1,1] neg_lo:[1,0,0]
    ds_write_addtid_b32 v121 offset:3808
    ds_write_addtid_b32 v122 offset:4080
    v_pk_mul_f16 v133, v109, v123 op_sel_hi:[1,0]
    v_pk_fma_f16 v137, v109, v123, v133 op_sel:[1,1,0] op_sel_hi:[0,1,1] neg_lo:[1,0,0]
    v_pk_mul_f16 v134, v110, v123 op_sel_hi:[1,0]
    v_pk_fma_f16 v138, v110, v123, v134 op_sel:[1,1,0] op_sel_hi:[0,1,1] neg_lo:[1,0,0]
    ds_write_addtid_b32 v136 offset:4624
    ds_write_addtid_b32 v137 offset:4896
    v_pk_mul_f16 v133, v111, v123 op_sel_hi:[1,0]
    v_pk_fma_f16 v139, v111, v123, v133 op_sel:[1,1,0] op_sel_hi:[0,1,1] neg_lo:[1,0,0]
    v_pk_mul_f16 v134, v112, v123 op_sel_hi:[1,0]
    v_pk_fma_f16 v140, v112, v123, v134 op_sel:[1,1,0] op_sel_hi:[0,1,1] neg_lo:[1,0,0]
    ds_write_addtid_b32 v138 offset:5168
    ds_write_addtid_b32 v139 offset:5440
    v_pk_mul_f16 v133, v113, v123 op_sel_hi:[1,0]
    v_pk_fma_f16 v141, v113, v123, v133 op_sel:[1,1,0] op_sel_hi:[0,1,1] neg_lo:[1,0,0]
    v_pk_mul_f16 v134, v114, v123 op_sel_hi:[1,0]
    v_pk_fma_f16 v142, v114, v123, v134 op_sel:[1,1,0] op_sel_hi:[0,1,1] neg_lo:[1,0,0]
    ds_write_addtid_b32 v140 offset:5712
    ds_write_addtid_b32 v141 offset:5984
    v_pk_mul_f16 v133, v115, v123 op_sel_hi:[1,0]
    v_pk_fma_f16 v135, v115, v123, v133 op_sel:[1,1,0] op_sel_hi:[0,1,1] neg_lo:[1,0,0]
    v_pk_mul_f16 v134, v116, v123 op_sel_hi:[1,0]
    v_pk_fma_f16 v136, v116, v123, v134 op_sel:[1,1,0] op_sel_hi:[0,1,1] neg_lo:[1,0,0]
    ds_write_addtid_b32 v142 offset:6256
    ds_write_addtid_b32 v135 offset:6528
    v_pk_mul_f16 v133, v117, v123 op_sel_hi:[1,0]
    v_pk_fma_f16 v137, v117, v123, v133 op_sel:[1,1,0] op_sel_hi:[0,1,1] neg_lo:[1,0,0]
    v_pk_mul_f16 v134, v118, v123 op_sel_hi:[1,0]
    v_pk_fma_f16 v138, v118, v123, v134 op_sel:[1,1,0] op_sel_hi:[0,1,1] neg_lo:[1,0,0]
    ds_write_addtid_b32 v136 offset:6800
    ds_write_addtid_b32 v137 offset:7072
    v_pk_mul_f16 v133, v119, v123 op_sel_hi:[1,0]
    v_pk_fma_f16 v139, v119, v123, v133 op_sel:[1,1,0] op_sel_hi:[0,1,1] neg_lo:[1,0,0]
    v_pk_mul_f16 v134, v120, v123 op_sel_hi:[1,0]
    v_pk_fma_f16 v140, v120, v123, v134 op_sel:[1,1,0] op_sel_hi:[0,1,1] neg_lo:[1,0,0]
    ds_write_addtid_b32 v138 offset:7344
    ds_write_addtid_b32 v139 offset:7616
    v_pk_mul_f16 v133, v121, v123 op_sel_hi:[1,0]
    v_pk_fma_f16 v141, v121, v123, v133 op_sel:[1,1,0] op_sel_hi:[0,1,1] neg_lo:[1,0,0]
    v_pk_mul_f16 v134, v122, v123 op_sel_hi:[1,0]
    v_pk_fma_f16 v142, v122, v123, v134 op_sel:[1,1,0] op_sel_hi:[0,1,1] neg_lo:[1,0,0]
    ds_write_addtid_b32 v140 offset:7888
    ds_write_addtid_b32 v141 offset:8160
    v_pk_mul_f32 v[96:97], v[96:97], s[54:55] op_sel_hi:[1,0]
    v_cvt_pk_f16_f32 v124, v96, -v97
    v_pk_mul_f16 v133, v124, v102 op_sel_hi:[1,0]
    v_pk_fma_f16 v125, v124, v102, v133 op_sel:[1,1,0] op_sel_hi:[0,1,1] neg_hi:[1,0,0]
    ds_write_addtid_b32 v142 offset:8432
    ds_write_addtid_b32 v124 offset:12784
    v_pk_mul_f16 v134, v124, v103 op_sel_hi:[1,0]
    v_pk_fma_f16 v126, v124, v103, v134 op_sel:[1,1,0] op_sel_hi:[0,1,1] neg_hi:[1,0,0]
    v_pk_mul_f16 v133, v125, v103 op_sel_hi:[1,0]
    v_pk_fma_f16 v127, v125, v103, v133 op_sel:[1,1,0] op_sel_hi:[0,1,1] neg_hi:[1,0,0]
    ds_write_addtid_b32 v125 offset:10064
    ds_write_addtid_b32 v126 offset:13872
    v_pk_mul_f16 v134, v124, v104 op_sel_hi:[1,0]
    v_pk_fma_f16 v128, v124, v104, v134 op_sel:[1,1,0] op_sel_hi:[0,1,1] neg_hi:[1,0,0]
    v_pk_mul_f16 v133, v125, v104 op_sel_hi:[1,0]
    v_pk_fma_f16 v135, v125, v104, v133 op_sel:[1,1,0] op_sel_hi:[0,1,1] neg_hi:[1,0,0]
    ds_write_addtid_b32 v127 offset:14144
    ds_write_addtid_b32 v128 offset:9520
    v_pk_mul_f16 v134, v126, v104 op_sel_hi:[1,0]
    v_pk_fma_f16 v129, v126, v104, v134 op_sel:[1,1,0] op_sel_hi:[0,1,1] neg_hi:[1,0,0]
    v_pk_mul_f16 v133, v127, v104 op_sel_hi:[1,0]
    v_pk_fma_f16 v136, v127, v104, v133 op_sel:[1,1,0] op_sel_hi:[0,1,1] neg_hi:[1,0,0]
    ds_write_addtid_b32 v135 offset:9792
    ds_write_addtid_b32 v129 offset:11152
    v_pk_mul_f16 v134, v124, v108 op_sel_hi:[1,0]
    v_pk_fma_f16 v130, v124, v108, v134 op_sel:[1,1,0] op_sel_hi:[0,1,1] neg_hi:[1,0,0]
    v_pk_mul_f16 v133, v124, v105 op_sel_hi:[1,0]
    v_pk_fma_f16 v137, v124, v105, v133 op_sel:[1,1,0] op_sel_hi:[0,1,1] neg_hi:[1,0,0]
    ds_write_addtid_b32 v136 offset:10880
    ds_write_addtid_b32 v130 offset:14416
    v_pk_mul_f16 v134, v126, v105 op_sel_hi:[1,0]
    v_pk_fma_f16 v138, v126, v105, v134 op_sel:[1,1,0] op_sel_hi:[0,1,1] neg_hi:[1,0,0]
    v_pk_mul_f16 v133, v128, v105 op_sel_hi:[1,0]
    v_pk_fma_f16 v139, v128, v105, v133 op_sel:[1,1,0] op_sel_hi:[0,1,1] neg_hi:[1,0,0]
    ds_write_addtid_b32 v137 offset:11968
    ds_write_addtid_b32 v138 offset:12512
    v_pk_mul_f16 v134, v129, v105 op_sel_hi:[1,0]
    v_pk_fma_f16 v140, v129, v105, v134 op_sel:[1,1,0] op_sel_hi:[0,1,1] neg_hi:[1,0,0]
    v_pk_mul_f16 v133, v130, v105 op_sel_hi:[1,0]
    v_pk_fma_f16 v141, v130, v105, v133 op_sel:[1,1,0] op_sel_hi:[0,1,1] neg_hi:[1,0,0]
    ds_write_addtid_b32 v139 offset:11696
    ds_write_addtid_b32 v140 offset:10608
    v_pk_mul_f16 v134, v128, v106 op_sel_hi:[1,0]
    v_pk_fma_f16 v131, v128, v106, v134 op_sel:[1,1,0] op_sel_hi:[0,1,1] neg_hi:[1,0,0]
    v_pk_mul_f16 v133, v130, v106 op_sel_hi:[1,0]
    v_pk_fma_f16 v132, v130, v106, v133 op_sel:[1,1,0] op_sel_hi:[0,1,1] neg_hi:[1,0,0]
    ds_write_addtid_b32 v141 offset:9248
    ds_write_addtid_b32 v131 offset:12240
    v_pk_mul_f16 v134, v131, v105 op_sel_hi:[1,0]
    v_pk_fma_f16 v142, v131, v105, v134 op_sel:[1,1,0] op_sel_hi:[0,1,1] neg_hi:[1,0,0]
    v_pk_mul_f16 v133, v132, v105 op_sel_hi:[1,0]
    v_pk_fma_f16 v135, v132, v105, v133 op_sel:[1,1,0] op_sel_hi:[0,1,1] neg_hi:[1,0,0]
    ds_write_addtid_b32 v132 offset:13600
    ds_write_addtid_b32 v142 offset:11424
    v_pk_mul_f16 v134, v130, v107 op_sel_hi:[1,0]
    v_pk_fma_f16 v125, v130, v107, v134 op_sel:[1,1,0] op_sel_hi:[0,1,1] neg_hi:[1,0,0]
    v_pk_mul_f16 v133, v125, v105 op_sel_hi:[1,0]
    v_pk_fma_f16 v136, v125, v105, v133 op_sel:[1,1,0] op_sel_hi:[0,1,1] neg_hi:[1,0,0]
    ds_write_addtid_b32 v135 offset:10336
    ds_write_addtid_b32 v125 offset:8976
    ds_write_addtid_b32 v136 offset:13328
    s_cmp_eq_u32 s33, 0
    s_cbranch_scc1 L_skip1
    v_pk_mul_f16 v134, v125, v106 op_sel_hi:[1,0]
    v_pk_fma_f16 v127, v125, v106, v134 op_sel:[1,1,0] op_sel_hi:[0,1,1] neg_hi:[1,0,0]
    v_pk_mul_f16 v133, v127, v105 op_sel_hi:[1,0]
    v_pk_fma_f16 v137, v127, v105, v133 op_sel:[1,1,0] op_sel_hi:[0,1,1] neg_hi:[1,0,0]
    ds_write_addtid_b32 v127 offset:8704
    ds_write_addtid_b32 v137 offset:13056
L_skip1:
    buffer_load_dwordx4 v[244:247], v13, s[24:27], s34 offen
    s_cmp_eq_u32 s33, 0
    s_cbranch_scc0 L_role1
    s_branch L_role0
.p2align 12
L_role0:
    s_cbranch_execz L_back1
    s_mov_b32 m0, s36
    s_mov_b32 s56, 0
    ds_read_b128 v[144:147], v18 offset:0
    ds_read_b128 v[148:151], v17 offset:0
    ds_read_b128 v[152:155], v18 offset:32
    v_lshrrev_b32 v11, 5, v1
    v_lshlrev_b32 v0, 4, v11
    v_alignbit_b32 v0, s48, s48, v0
    v_add_u32_sdwa v7, s43, v229 dst_sel:DWORD dst_unused:UNUSED_PAD src0_sel:DWORD src1_sel:WORD_1
    s_waitcnt lgkmcnt(1)
    v_mfma_f32_32x32x16_f16 v[208:223], v[144:147], v[148:151], v[208:223]
    s_setprio 2
    ds_read_b128 v[156:159], v17 offset:32
    ds_read_b128 v[160:163], v18 offset:64
    ds_read_b128 v[164:167], v17 offset:64
    v_lshl_add_u32 v9, v11, 3, s34
    v_lshl_add_u32 v9, v7, 11, v9
    v_add_u32 v7, 0x02020202, v0
    v_cndmask_b32 v19, 0, v19, s[52:53]
    v_add_u32_sdwa v2, s37, v226 dst_sel:DWORD dst_unused:UNUSED_PAD src0_sel:DWORD src1_sel:WORD_0
    v_add_u32_sdwa v3, s35, v226 dst_sel:DWORD dst_unused:UNUSED_PAD src0_sel:DWORD src1_sel:WORD_1
    s_waitcnt lgkmcnt(2)
    v_mfma_f32_32x32x16_f16 v[208:223], v[152:155], v[156:159], v[208:223]
    ds_read_b128 v[168:171], v18 offset:96
    ds_read_b128 v[172:175], v17 offset:96
    ds_read_b128 v[176:179], v18 offset:128
    v_add_u32_sdwa v4, s35, v227 dst_sel:DWORD dst_unused:UNUSED_PAD src0_sel:DWORD src1_sel:WORD_0
    v_add_u32_sdwa v20, s35, v228 dst_sel:DWORD dst_unused:UNUSED_PAD src0_sel:DWORD src1_sel:WORD_1
    v_add_u32_sdwa v5, s35, v227 dst_sel:DWORD dst_unused:UNUSED_PAD src0_sel:DWORD src1_sel:WORD_1
    v_mov_b32 v21, v231
    v_add_u32_sdwa v6, s35, v228 dst_sel:DWORD dst_unused:UNUSED_PAD src0_sel:DWORD src1_sel:WORD_0
    v_add_u32_sdwa v22, s35, v229 dst_sel:DWORD dst_unused:UNUSED_PAD src0_sel:DWORD src1_sel:WORD_0
    s_waitcnt lgkmcnt(3)
    v_mfma_f32_32x32x16_f16 v[208:223], v[160:163], v[164:167], v[208:223]
    ds_read_b128 v[180:183], v17 offset:128
    ds_read_b128 v[184:187], v18 offset:160
    ds_read_b128 v[188:191], v17 offset:160
    s_waitcnt vmcnt(2)
    v_perm_b32 v24, v60, v56, v0
    v_perm_b32 v25, v60, v56, v7
    v_perm_b32 v26, v61, v57, v0
    v_perm_b32 v27, v61, v57, v7
    v_add_u32_sdwa v8, s58, v230 dst_sel:DWORD dst_unused:UNUSED_PAD src0_sel:DWORD src1_sel:WORD_0
    s_waitcnt lgkmcnt(4)
    v_mfma_f32_32x32x16_f16 v[208:223], v[168:171], v[172:175], v[208:223]
    s_setprio 1
    ds_write_addtid_b32 v24 offset:0
    ds_write_addtid_b32 v25 offset:4160
    ds_write_addtid_b32 v26 offset:8320
    v_perm_b32 v24, v62, v58, v0
    v_perm_b32 v25, v62, v58, v7
    v_perm_b32 v26, v63, v59, v0
    s_waitcnt lgkmcnt(5)
    v_mfma_f32_32x32x16_f16 v[208:223], v[176:179], v[180:183], v[208:223]
    ds_write_addtid_b32 v27 offset:12480
    ds_write_addtid_b32 v24 offset:16640
    ds_read_b128 v[192:195], v18 offset:192
    v_perm_b32 v27, v63, v59, v7
    s_waitcnt lgkmcnt(6)
    v_mfma_f32_32x32x16_f16 v[208:223], v[184:187], v[188:191], v[208:223]
    ds_write_addtid_b32 v25 offset:20800
    ds_read_b128 v[196:199], v17 offset:192
    ds_write_addtid_b32 v26 offset:24960
    s_waitcnt lgkmcnt(1)
    v_mfma_f32_32x32x16_f16 v[208:223], v[192:195], v[196:199], v[208:223]
    s_setprio 0
    ds_read_b128 v[200:203], v18 offset:224
    ds_write_addtid_b32 v27 offset:29120
    s_mov_b32 m0, s35
    ds_read_b128 v[204:207], v17 offset:224
    s_waitcnt lgkmcnt(0)
    v_mfma_f32_32x32x16_f16 v[208:223], v[200:203], v[204:207], v[208:223]
    s_barrier
    ds_read_b128 v[224:227], v2 offset:1024
    ds_read_b128 v[228:231], v2 offset:1536
    ds_read_b128 v[12:15], v2 offset:544
    v_mul_u32_u24 v11, 65280, v11
    v_add_u32 v8, v8, v11
    s_nop 5
    v_mul_f32 v215, s55, v215
    v_mul_f32 v216, s55, v216
    v_cvt_pk_bf16_f32 v248, v216, v215
    v_mul_f32 v209, s55, v209
    ds_write_addtid_b32 v248 offset:544
    ds_write_addtid_b32 v248 offset:2724
    v_mul_f32 v210, s55, v210
    v_cvt_pk_bf16_f32 v249, v210, v209
    v_mul_f32 v211, s55, v211
    v_cvt_pk_bf16_f32 v250, v211, v210
    s_waitcnt lgkmcnt(2)
    v_mfma_f32_16x16x32_bf16 v[232:235], v[224:227], v[28:31], 0
    s_setprio 2
    ds_write_addtid_b32 v249 offset:1088
    ds_write_addtid_b32 v249 offset:3268
    v_mul_f32 v212, s55, v212
    v_cvt_pk_bf16_f32 v251, v212, v211
    v_mfma_f32_16x16x32_bf16 v[236:239], v[224:227], v[32:35], 0
    ds_write_addtid_b32 v250 offset:1360
    ds_write_addtid_b32 v250 offset:3540
    v_mul_f32 v213, s55, v213
    v_readlane_b32 s38, v248, 63
    v_mfma_f32_16x16x32_bf16 v[176:179], v[224:227], v[36:39], 0
    ds_write_addtid_b32 v251 offset:1632
    ds_write_addtid_b32 v251 offset:3812
    v_cvt_pk_bf16_f32 v248, v213, v212
    v_mul_f32 v214, s55, v214
    v_mfma_f32_16x16x32_bf16 v[180:183], v[224:227], v[40:43], 0
    ds_write_addtid_b32 v248 offset:1904
    ds_write_addtid_b32 v248 offset:4084
    v_cvt_pk_bf16_f32 v249, v214, v213
    v_mul_f32 v218, s55, v218
    v_mfma_f32_16x16x32_bf16 v[200:203], v[228:231], v[28:31], 0
    ds_write_addtid_b32 v249 offset:2176
    ds_write_addtid_b32 v249 offset:4356
    v_cvt_pk_bf16_f32 v250, v215, v214
    v_mul_f32 v217, s55, v217
    v_mfma_f32_16x16x32_bf16 v[204:207], v[228:231], v[32:35], 0
    ds_write_addtid_b32 v250 offset:272
    ds_write_addtid_b32 v250 offset:2452
    v_fma_f32 v208, s55, v208, v19
    v_mov_b32 v252, v218
    ds_read_b128 v[16:19], v2 offset:608
    ds_read_b128 v[212:215], v2 offset:672
    v_cvt_pk_bf16_f32 v251, v209, v208
    v_mov_b32_dpp v252, v217 wave_shl:1 row_mask:0xf bank_mask:0xf
    v_cvt_pk_bf16_f32 v252, v218, v252
    v_cvt_pk_bf16_f32 v255, v208, v217
    ds_write_addtid_b32 v251 offset:816
    ds_write_addtid_b32 v252 offset:14808
    ds_write_addtid_b32 v251 offset:2996
    v_readlane_b32 s39, v255, 0
    v_mov_b32 v255, s38
    s_nop 0
    v_perm_b32 v255, v255, s39, v21
    v_cvt_pk_bf16_f32 v184, v235, v239
    ds_write_addtid_b32 v252 offset:15184
    s_mov_b32 m0, s50
    ds_write_b32 v20, v255
    v_cvt_pk_bf16_f32 v186, v234, v238
    v_cvt_pk_bf16_f32 v188, v233, v237
    v_cvt_pk_bf16_f32 v190, v232, v236
    v_cvt_pk_bf16_f32 v185, v179, v183
    v_mfma_f32_16x16x32_bf16 v[232:235], v[228:231], v[36:39], 0
    ds_read_b128 v[144:147], v5 offset:0
    ds_read_b128 v[148:151], v5 offset:16
    v_cvt_pk_bf16_f32 v187, v178, v182
    v_cvt_pk_bf16_f32 v189, v177, v181
    v_mfma_f32_16x16x32_bf16 v[236:239], v[228:231], v[40:43], 0
    ds_read_b64 v[108:109], v3 offset:128
    ds_read_b64 v[110:111], v4 offset:128
    v_cvt_pk_bf16_f32 v191, v176, v180
    v_mul_f32 v219, s55, v219
    ds_read_b64 v[140:141], v3 offset:256
    ds_read_b64 v[142:143], v4 offset:256
    ds_read_b64 v[104:105], v3 offset:112
    v_cvt_pk_bf16_f32 v253, v219, v220
    v_cvt_pk_bf16_f32 v192, v203, v207
    v_cvt_pk_bf16_f32 v194, v202, v206
    v_cvt_pk_bf16_f32 v196, v201, v205
    ds_read_b64 v[106:107], v4 offset:112
    ds_read_b64 v[136:137], v3 offset:240
    ds_read_b64 v[138:139], v4 offset:240
    v_cvt_pk_bf16_f32 v193, v235, v239
    v_cvt_pk_bf16_f32 v195, v234, v238
    v_cvt_pk_bf16_f32 v198, v200, v204
    v_cvt_pk_bf16_f32 v197, v233, v237
    s_waitcnt lgkmcnt(8)
    v_mfma_f32_16x16x32_bf16 v[64:67], v[184:187], v[144:147], 0
    ds_read_b64 v[100:101], v3 offset:96
    ds_read_b64 v[102:103], v4 offset:96
    v_mfma_f32_16x16x32_bf16 v[64:67], v[188:191], v[148:151], v[64:67]
    ds_read_b64 v[132:133], v3 offset:224
    ds_read_b64 v[134:135], v4 offset:224
    s_waitcnt lgkmcnt(7)
    v_mfma_f32_16x16x32_bf16 v[56:59], v[108:111], v[12:15], 0
    ds_read_b64 v[96:97], v3 offset:80
    ds_read_b64 v[98:99], v4 offset:80
    v_mfma_f32_16x16x32_bf16 v[60:63], v[140:143], v[12:15], 0
    ds_read_b128 v[208:211], v2 offset:736
    ds_read_b64 v[128:129], v3 offset:208
    v_mfma_f32_16x16x32_bf16 v[176:179], v[224:227], v[44:47], 0
    ds_read_b64 v[130:131], v4 offset:208
    ds_read_b64 v[92:93], v3 offset:64
    v_mfma_f32_16x16x32_bf16 v[180:183], v[224:227], v[48:51], 0
    ds_read_b64 v[94:95], v4 offset:64
    ds_read_b128 v[220:223], v2 offset:800
    s_waitcnt lgkmcnt(6)
    v_mfma_f32_16x16x32_bf16 v[56:59], v[104:107], v[16:19], v[56:59]
    s_setprio 1
    ds_read_b64 v[124:125], v3 offset:192
    ds_read_b64 v[126:127], v4 offset:192
    v_mfma_f32_16x16x32_bf16 v[60:63], v[136:139], v[16:19], v[60:63]
    ds_read_b64 v[88:89], v3 offset:48
    ds_read_b64 v[90:91], v4 offset:48
    v_mfma_f32_16x16x32_bf16 v[56:59], v[100:103], v[212:215], v[56:59]
    ds_read_b128 v[12:15], v2 offset:864
    ds_read_b64 v[120:121], v3 offset:176
    v_mfma_f32_16x16x32_bf16 v[60:63], v[132:135], v[212:215], v[60:63]
    ds_read_b64 v[122:123], v4 offset:176
    ds_read_b64 v[84:85], v3 offset:32
    v_mfma_f32_16x16x32_bf16 v[68:71], v[192:195], v[144:147], 0
    ds_read_b64 v[86:87], v4 offset:32
    ds_read_b128 v[16:19], v2 offset:928
    s_waitcnt lgkmcnt(6)
    v_mfma_f32_16x16x32_bf16 v[56:59], v[96:99], v[208:211], v[56:59]
    ds_read_b64 v[116:117], v3 offset:160
    ds_read_b64 v[118:119], v4 offset:160
    v_mfma_f32_16x16x32_bf16 v[60:63], v[128:131], v[208:211], v[60:63]
    ds_read_b128 v[212:215], v2 offset:992
    ds_read_b64 v[80:81], v3 offset:16
    v_mfma_f32_16x16x32_bf16 v[56:59], v[92:95], v[220:223], v[56:59]
    ds_read_b64 v[82:83], v4 offset:16
    ds_read_b64 v[112:113], v3 offset:144
    v_cvt_pk_bf16_f32 v199, v232, v236
    s_nop 1
    v_mfma_f32_16x16x32_bf16 v[68:71], v[196:199], v[148:151], v[68:71]
    ds_read_b64 v[114:115], v4 offset:144
    v_cvt_pk_bf16_f32 v254, -v218, v10
    s_nop 0
    v_readlane_b32 s57, v254, 63
    v_mfma_f32_16x16x32_bf16 v[60:63], v[124:127], v[220:223], v[60:63]
    ds_read_b128 v[208:211], v2 offset:1120
    v_mul_u32_u24 v52, s57, v52
    v_mul_u32_u24 v53, s57, v53
    s_waitcnt lgkmcnt(4)
    v_mfma_f32_16x16x32_bf16 v[56:59], v[88:91], v[12:15], v[56:59]
    ds_read_b64 v[76:77], v3 offset:0
    v_mul_u32_u24 v54, s57, v54
    v_mul_u32_u24 v55, s57, v55
    v_mfma_f32_16x16x32_bf16 v[60:63], v[120:123], v[12:15], v[60:63]
    ds_read_b64 v[78:79], v4 offset:0
    v_cvt_pk_bf16_f32 v172, v179, v183
    v_cvt_pk_bf16_f32 v173, v178, v182
    v_mfma_f32_16x16x32_bf16 v[56:59], v[84:87], v[16:19], v[56:59]
    ds_read_b128 v[220:223], v2 offset:1056
    v_cvt_pk_bf16_f32 v174, v177, v181
    v_cvt_pk_bf16_f32 v175, v176, v180
    v_mfma_f32_16x16x32_bf16 v[60:63], v[116:119], v[16:19], v[60:63]
    s_setprio 0
    ds_read_b128 v[12:15], v2 offset:1184
    s_waitcnt lgkmcnt(3)
    v_mfma_f32_16x16x32_bf16 v[56:59], v[80:83], v[212:215], v[56:59]
    ds_read_b128 v[152:155], v5 offset:128
    v_mfma_f32_16x16x32_bf16 v[60:63], v[112:115], v[212:215], v[60:63]
    ds_read_b128 v[16:19], v2 offset:1248
    v_mfma_f32_16x16x32_bf16 v[60:63], v[104:107], v[208:211], v[60:63]
    ds_read_b128 v[212:215], v2 offset:1312
    v_mfma_f32_16x16x32_bf16 v[64:67], v[136:139], v[208:211], v[64:67]
    ds_read_b128 v[156:159], v5 offset:144
    s_waitcnt vmcnt(0)
    v_perm_b32 v24, v244, v240, v0
    v_perm_b32 v25, v244, v240, v7
    s_waitcnt lgkmcnt(3)
    v_mfma_f32_16x16x32_bf16 v[56:59], v[76:79], v[220:223], v[56:59]
    ds_write_addtid_b32 v24 offset:0
    ds_write_addtid_b32 v25 offset:4160
    v_perm_b32 v26, v245, v241, v0
    v_perm_b32 v27, v245, v241, v7
    v_mfma_f32_16x16x32_bf16 v[60:63], v[108:111], v[220:223], v[60:63]
    ds_write_addtid_b32 v26 offset:8320
    ds_write_addtid_b32 v27 offset:12480
    v_perm_b32 v24, v246, v242, v0
    v_perm_b32 v25, v246, v242, v7
    v_mfma_f32_16x16x32_bf16 v[64:67], v[140:143], v[220:223], v[64:67]
    ds_write_addtid_b32 v24 offset:16640
    ds_write_addtid_b32 v25 offset:20800
    v_perm_b32 v26, v247, v243, v0
    v_perm_b32 v27, v247, v243, v7
    v_cvt_pk_bf16_f32 v24, v56, v57
    v_cvt_pk_bf16_f32 v25, v58, v59
    v_mfma_f32_16x16x32_bf16 v[60:63], v[100:103], v[12:15], v[60:63]
    ds_write_addtid_b32 v26 offset:24960
    ds_write_addtid_b32 v27 offset:29120
    s_mov_b32 m0, s35
    v_mfma_f32_16x16x32_bf16 v[64:67], v[132:135], v[12:15], v[64:67]
    ds_write_addtid_b32 v24 offset:4896
    ds_write_addtid_b32 v25 offset:5152
    v_mfma_f32_16x16x32_bf16 v[68:71], v[184:187], v[152:155], v[68:71]
    ds_read_b128 v[208:211], v2 offset:1376
    ds_read_b128 v[220:223], v2 offset:1440
    s_waitcnt lgkmcnt(6)
    v_mfma_f32_16x16x32_bf16 v[68:71], v[188:191], v[156:159], v[68:71]
    ds_read_b128 v[12:15], v2 offset:1504
    v_mfma_f32_16x16x32_bf16 v[60:63], v[96:99], v[16:19], v[60:63]
    s_waitcnt lgkmcnt(3)
    s_barrier
    ds_read_b64_tr_b16 v[248:249], v8 offset:0
    ds_read_b128 v[16:19], v2 offset:1568
    v_mfma_f32_16x16x32_bf16 v[60:63], v[92:95], v[212:215], v[60:63]
    s_setprio 2
    ds_read_b128 v[212:215], v2 offset:1632
    s_waitcnt lgkmcnt(4)
    v_mfma_f32_16x16x32_bf16 v[60:63], v[88:91], v[208:211], v[60:63]
    ds_write_b16 v22, v253
    v_mfma_f32_16x16x32_bf16 v[64:67], v[120:123], v[208:211], v[64:67]
    s_waitcnt lgkmcnt(3)
    buffer_store_dwordx2 v[248:249], v9, s[28:31], s56 offen
    s_mov_b32 s56, 524288
    v_mfma_f32_16x16x32_bf16 v[60:63], v[84:87], v[220:223], v[60:63]
    v_mfma_f32_16x16x32_bf16 v[64:67], v[116:119], v[220:223], v[64:67]
    ds_read_b128 v[208:211], v2 offset:1312
    v_mfma_f32_16x16x32_bf16 v[60:63], v[80:83], v[12:15], v[60:63]
    s_setprio 1
    ds_read_b128 v[220:223], v2 offset:1248
    v_mfma_f32_16x16x32_bf16 v[64:67], v[112:115], v[12:15], v[64:67]
    ds_read_b128 v[12:15], v2 offset:1696
    s_waitcnt lgkmcnt(3)
    v_mfma_f32_16x16x32_bf16 v[60:63], v[76:79], v[16:19], v[60:63]
    ds_read2_b32 v[168:169], v6 offset0:0 offset1:1
    v_mfma_f32_16x16x32_bf16 v[64:67], v[108:111], v[16:19], v[64:67]
    ds_read_b128 v[16:19], v2 offset:1760
    s_nop 4
    v_cvt_pk_bf16_f32 v26, v60, v61
    v_cvt_pk_bf16_f32 v27, v62, v63
    v_mfma_f32_16x16x32_bf16 v[64:67], v[104:107], v[212:215], v[64:67]
    ds_write_addtid_b32 v26 offset:5408
    ds_read_b128 v[212:215], v2 offset:1824
    s_waitcnt lgkmcnt(4)
    v_mfma_f32_16x16x32_bf16 v[64:67], v[124:127], v[208:211], v[64:67]
    s_setprio 0
    ds_write_addtid_b32 v27 offset:5664
    v_mfma_f32_16x16x32_bf16 v[64:67], v[128:131], v[220:223], v[64:67]
    ds_read_b128 v[208:211], v2 offset:1888
    v_mfma_f32_16x16x32_bf16 v[64:67], v[100:103], v[12:15], v[64:67]
    ds_read_b128 v[220:223], v2 offset:1952
    s_waitcnt lgkmcnt(3)
    v_mfma_f32_16x16x32_bf16 v[64:67], v[96:99], v[16:19], v[64:67]
    s_waitcnt lgkmcnt(2)
    s_barrier
    ds_read_b64_tr_b16 v[252:253], v8 offset:512
    v_mfma_f32_16x16x32_bf16 v[68:71], v[128:131], v[16:19], v[68:71]
    s_setprio 2
    ds_read_b128 v[12:15], v2 offset:2016
    v_mfma_f32_16x16x32_bf16 v[64:67], v[92:95], v[212:215], v[64:67]
    ds_read_b128 v[16:19], v2 offset:2080
    v_mfma_f32_16x16x32_bf16 v[68:71], v[124:127], v[212:215], v[68:71]
    ds_read_b128 v[212:215], v2 offset:1632
    s_waitcnt lgkmcnt(3)
    buffer_store_dwordx2 v[252:253], v9, s[28:31], s56 offen
    s_mov_b32 s56, 1048576
    v_mfma_f32_16x16x32_bf16 v[64:67], v[88:91], v[208:211], v[64:67]
    v_mfma_f32_16x16x32_bf16 v[64:67], v[84:87], v[220:223], v[64:67]
    ds_read_b128 v[208:211], v2 offset:2080
    s_waitcnt lgkmcnt(2)
    v_mfma_f32_16x16x32_bf16 v[64:67], v[80:83], v[12:15], v[64:67]
    s_setprio 1
    ds_read_b128 v[220:223], v2 offset:2016
    v_mfma_f32_16x16x32_bf16 v[72:75], v[52:55], v[224:227], 0
    ds_read_b128 v[12:15], v2 offset:1888
    v_mfma_f32_16x16x32_bf16 v[64:67], v[76:79], v[16:19], v[64:67]
    ds_read2_b32 v[170:171], v6 offset0:2 offset1:3
    v_mfma_f32_16x16x32_bf16 v[72:75], v[140:143], v[16:19], v[72:75]
    ds_read_b128 v[16:19], v2 offset:1952
    s_nop 4
    v_cvt_pk_bf16_f32 v24, v64, v65
    v_cvt_pk_bf16_f32 v25, v66, v67
    s_waitcnt lgkmcnt(3)
    v_mfma_f32_16x16x32_bf16 v[68:71], v[136:139], v[212:215], v[68:71]
    s_setprio 0
    ds_write_addtid_b32 v24 offset:5920
    ds_write_addtid_b32 v25 offset:6176
    v_mfma_f32_16x16x32_bf16 v[68:71], v[108:111], v[208:211], v[68:71]
    ds_read_b128 v[212:215], v2 offset:1568
    v_mfma_f32_16x16x32_bf16 v[68:71], v[112:115], v[220:223], v[68:71]
    ds_read_b128 v[208:211], v2 offset:1696
    s_waitcnt lgkmcnt(4)
    v_mfma_f32_16x16x32_bf16 v[68:71], v[120:123], v[12:15], v[68:71]
    s_waitcnt lgkmcnt(2)
    s_barrier
    ds_read_b128 v[220:223], v2 offset:2144
    v_mfma_f32_16x16x32_bf16 v[68:71], v[116:119], v[16:19], v[68:71]
    s_setprio 2
    ds_read_b128 v[12:15], v2 offset:2208
    s_waitcnt lgkmcnt(3)
    v_mfma_f32_16x16x32_bf16 v[68:71], v[140:143], v[212:215], v[68:71]
    ds_read_b128 v[16:19], v2 offset:2272
    ds_read_b64_tr_b16 v[248:249], v8 offset:1024
    s_waitcnt lgkmcnt(4)
    v_mfma_f32_16x16x32_bf16 v[68:71], v[132:135], v[208:211], v[68:71]
    ds_read_b128 v[212:215], v2 offset:2336
    s_waitcnt lgkmcnt(4)
    v_mfma_f32_16x16x32_bf16 v[68:71], v[104:107], v[220:223], v[68:71]
    ds_read_b128 v[208:211], v2 offset:2400
    v_mfma_f32_16x16x32_bf16 v[72:75], v[136:139], v[220:223], v[72:75]
    ds_read_b128 v[220:223], v2 offset:2464
    s_waitcnt lgkmcnt(3)
    buffer_store_dwordx2 v[248:249], v9, s[28:31], s56 offen
    s_mov_b32 s56, 1572864
    v_mfma_f32_16x16x32_bf16 v[68:71], v[100:103], v[12:15], v[68:71]
    v_mfma_f32_16x16x32_bf16 v[68:71], v[96:99], v[16:19], v[68:71]
    ds_read_b128 v[12:15], v2 offset:2528
    v_mfma_f32_16x16x32_bf16 v[72:75], v[128:131], v[16:19], v[72:75]
    s_setprio 1
    ds_read_b128 v[16:19], v2 offset:2592
    s_waitcnt lgkmcnt(2)
    v_mfma_f32_16x16x32_bf16 v[68:71], v[92:95], v[212:215], v[68:71]
    ds_read_b128 v[212:215], v2 offset:2784
    v_mfma_f32_16x16x32_bf16 v[68:71], v[88:91], v[208:211], v[68:71]
    ds_read_b128 v[228:231], v2 offset:2048
    v_mfma_f32_16x16x32_bf16 v[68:71], v[84:87], v[220:223], v[68:71]
    ds_read_b128 v[208:211], v2 offset:2656
    v_mfma_f32_16x16x32_bf16 v[72:75], v[116:119], v[220:223], v[72:75]
    ds_read_b128 v[220:223], v2 offset:2720
    s_waitcnt lgkmcnt(3)
    v_mfma_f32_16x16x32_bf16 v[68:71], v[80:83], v[12:15], v[68:71]
    ds_read_b128 v[160:163], v5 offset:256
    v_mfma_f32_16x16x32_bf16 v[72:75], v[112:115], v[12:15], v[72:75]
    ds_read_b128 v[12:15], v2 offset:2848
    v_mfma_f32_16x16x32_bf16 v[68:71], v[76:79], v[16:19], v[68:71]
    s_setprio 0
    ds_read_b128 v[164:167], v5 offset:272
    v_mfma_f32_16x16x32_bf16 v[72:75], v[108:111], v[16:19], v[72:75]
    ds_read_b128 v[16:19], v2 offset:2912
    s_nop 3
    v_cvt_pk_bf16_f32 v26, v68, v69
    v_cvt_pk_bf16_f32 v27, v70, v71
    v_mfma_f32_16x16x32_bf16 v[72:75], v[96:99], v[212:215], v[72:75]
    ds_write_addtid_b32 v26 offset:6432
    ds_write_addtid_b32 v27 offset:6688
    v_mfma_f32_16x16x32_bf16 v[72:75], v[172:175], v[168:171], v[72:75]
    ds_read_b128 v[212:215], v2 offset:2976
    s_waitcnt lgkmcnt(4)
    v_mfma_f32_16x16x32_bf16 v[240:243], v[228:231], v[28:31], 0
    v_mfma_f32_16x16x32_bf16 v[244:247], v[228:231], v[32:35], 0
    s_waitcnt lgkmcnt(1)
    s_barrier
    ds_read_b64_tr_b16 v[252:253], v8 offset:1536
    v_mfma_f32_16x16x32_bf16 v[232:235], v[228:231], v[36:39], 0
    s_setprio 2
    v_mfma_f32_16x16x32_bf16 v[236:239], v[228:231], v[40:43], 0
    s_nop 1
    v_cvt_pk_bf16_f32 v200, v243, v247
    v_cvt_pk_bf16_f32 v202, v242, v246
    v_mfma_f32_16x16x32_bf16 v[72:75], v[192:195], v[152:155], v[72:75]
    s_waitcnt lgkmcnt(0)
    buffer_store_dwordx2 v[252:253], v9, s[28:31], s56 offen
    s_mov_b32 s56, 2097152
    v_mfma_f32_16x16x32_bf16 v[72:75], v[196:199], v[156:159], v[72:75]
    v_cvt_pk_bf16_f32 v201, v235, v239
    v_cvt_pk_bf16_f32 v203, v234, v238
    v_mfma_f32_16x16x32_bf16 v[72:75], v[104:107], v[208:211], v[72:75]
    ds_read_b128 v[208:211], v2 offset:3040
    v_cvt_pk_bf16_f32 v204, v241, v245
    v_cvt_pk_bf16_f32 v206, v240, v244
    v_mfma_f32_16x16x32_bf16 v[72:75], v[100:103], v[220:223], v[72:75]
    ds_read_b128 v[220:223], v2 offset:3104
    v_cvt_pk_bf16_f32 v205, v233, v237
    v_cvt_pk_bf16_f32 v207, v232, v236
    v_mfma_f32_16x16x32_bf16 v[72:75], v[92:95], v[12:15], v[72:75]
    s_setprio 1
    ds_read_b128 v[12:15], v2 offset:2336
    v_mfma_f32_16x16x32_bf16 v[72:75], v[200:203], v[144:147], v[72:75]
    v_mfma_f32_16x16x32_bf16 v[72:75], v[204:207], v[148:151], v[72:75]
    v_mfma_f32_16x16x32_bf16 v[72:75], v[88:91], v[16:19], v[72:75]
    ds_read_b128 v[16:19], v2 offset:2208
    v_mfma_f32_16x16x32_bf16 v[72:75], v[84:87], v[212:215], v[72:75]
    ds_read_b128 v[212:215], v2 offset:2400
    v_mfma_f32_16x16x32_bf16 v[72:75], v[184:187], v[160:163], v[72:75]
    v_mfma_f32_16x16x32_bf16 v[72:75], v[188:191], v[164:167], v[72:75]
    s_setprio 0
    s_waitcnt lgkmcnt(1)
    v_mfma_f32_16x16x32_bf16 v[72:75], v[80:83], v[208:211], v[72:75]
    v_mfma_f32_16x16x32_bf16 v[72:75], v[76:79], v[220:223], v[72:75]
    v_mfma_f32_16x16x32_bf16 v[72:75], v[124:127], v[12:15], v[72:75]
    v_mfma_f32_16x16x32_bf16 v[72:75], v[132:135], v[16:19], v[72:75]
    s_waitcnt lgkmcnt(0)
    v_mfma_f32_16x16x32_bf16 v[72:75], v[120:123], v[212:215], v[72:75]
    s_nop 7
    v_cvt_pk_bf16_f32 v24, v72, v73
    v_cvt_pk_bf16_f32 v25, v74, v75
    ds_write_addtid_b32 v24 offset:6944
    ds_write_addtid_b32 v25 offset:7200
    s_waitcnt lgkmcnt(0)
    s_barrier
    ds_read_b64_tr_b16 v[248:249], v8 offset:2048
    s_waitcnt lgkmcnt(0)
    buffer_store_dwordx2 v[248:249], v9, s[28:31], s56 offen
    s_endpgm
.p2align 12
L_role1:
    s_cbranch_execz L_back1
    s_mov_b32 m0, s36
    s_mov_b32 s56, 2621440
    ds_read_b128 v[144:147], v18 offset:0
    ds_read_b128 v[148:151], v17 offset:0
    ds_read_b128 v[152:155], v18 offset:32
    v_lshrrev_b32 v11, 5, v1
    v_lshlrev_b32 v0, 4, v11
    v_alignbit_b32 v0, s48, s48, v0
    v_add_u32_sdwa v7, s43, v229 dst_sel:DWORD dst_unused:UNUSED_PAD src0_sel:DWORD src1_sel:WORD_1
    s_waitcnt lgkmcnt(1)
    v_mfma_f32_32x32x16_f16 v[208:223], v[144:147], v[148:151], v[208:223]
    s_setprio 3
    ds_read_b128 v[156:159], v17 offset:32
    ds_read_b128 v[160:163], v18 offset:64
    ds_read_b128 v[164:167], v17 offset:64
    v_lshl_add_u32 v9, v11, 3, s34
    v_lshl_add_u32 v9, v7, 11, v9
    v_add_u32 v7, 0x02020202, v0
    v_add_u32_sdwa v2, s37, v226 dst_sel:DWORD dst_unused:UNUSED_PAD src0_sel:DWORD src1_sel:WORD_0
    v_add_u32_sdwa v22, s35, v229 dst_sel:DWORD dst_unused:UNUSED_PAD src0_sel:DWORD src1_sel:WORD_0
    v_add_u32_sdwa v3, s35, v226 dst_sel:DWORD dst_unused:UNUSED_PAD src0_sel:DWORD src1_sel:WORD_1
    s_waitcnt lgkmcnt(2)
    v_mfma_f32_32x32x16_f16 v[208:223], v[152:155], v[156:159], v[208:223]
    ds_read_b128 v[168:171], v18 offset:96
    ds_read_b128 v[172:175], v17 offset:96
    ds_read_b128 v[176:179], v18 offset:128
    v_add_u32_sdwa v4, s35, v227 dst_sel:DWORD dst_unused:UNUSED_PAD src0_sel:DWORD src1_sel:WORD_0
    v_add_u32_sdwa v5, s35, v227 dst_sel:DWORD dst_unused:UNUSED_PAD src0_sel:DWORD src1_sel:WORD_1
    v_add_u32_sdwa v6, s35, v228 dst_sel:DWORD dst_unused:UNUSED_PAD src0_sel:DWORD src1_sel:WORD_0
    v_add_u32_sdwa v20, s35, v228 dst_sel:DWORD dst_unused:UNUSED_PAD src0_sel:DWORD src1_sel:WORD_1
    v_add_u32_sdwa v8, s58, v230 dst_sel:DWORD dst_unused:UNUSED_PAD src0_sel:DWORD src1_sel:WORD_0
    v_mov_b32 v21, v231
    s_waitcnt lgkmcnt(3)
    v_mfma_f32_32x32x16_f16 v[208:223], v[160:163], v[164:167], v[208:223]
    s_setprio 2
    ds_read_b128 v[180:183], v17 offset:128
    ds_read_b128 v[184:187], v18 offset:160
    ds_read_b128 v[188:191], v17 offset:160
    v_cndmask_b32 v19, 0, v19, s[52:53]
    s_waitcnt lgkmcnt(4)
    v_mfma_f32_32x32x16_f16 v[208:223], v[168:171], v[172:175], v[208:223]
    ds_read_b128 v[192:195], v18 offset:192
    ds_read_b128 v[196:199], v17 offset:192
    ds_read_b128 v[200:203], v18 offset:224
    s_waitcnt vmcnt(2)
    v_perm_b32 v24, v60, v56, v0
    v_perm_b32 v25, v60, v56, v7
    v_perm_b32 v26, v61, v57, v0
    v_perm_b32 v27, v61, v57, v7
    s_waitcnt lgkmcnt(5)
    v_mfma_f32_32x32x16_f16 v[208:223], v[176:179], v[180:183], v[208:223]
    s_setprio 1
    ds_write_addtid_b32 v24 offset:0
    ds_write_addtid_b32 v25 offset:4160
    ds_write_addtid_b32 v26 offset:8320
    v_perm_b32 v24, v62, v58, v0
    v_perm_b32 v25, v62, v58, v7
    v_perm_b32 v26, v63, v59, v0
    s_waitcnt lgkmcnt(6)
    v_mfma_f32_32x32x16_f16 v[208:223], v[184:187], v[188:191], v[208:223]
    ds_write_addtid_b32 v27 offset:12480
    ds_write_addtid_b32 v24 offset:16640
    ds_write_addtid_b32 v25 offset:20800
    v_perm_b32 v27, v63, v59, v7
    s_waitcnt lgkmcnt(7)
    v_mfma_f32_32x32x16_f16 v[208:223], v[192:195], v[196:199], v[208:223]
    s_setprio 0
    ds_read_b128 v[204:207], v17 offset:224
    ds_write_addtid_b32 v26 offset:24960
    ds_write_addtid_b32 v27 offset:29120
    s_mov_b32 m0, s35
    v_mul_u32_u24 v11, 65280, v11
    s_waitcnt lgkmcnt(2)
    v_mfma_f32_32x32x16_f16 v[208:223], v[200:203], v[204:207], v[208:223]
    s_waitcnt lgkmcnt(0)
    s_barrier
    ds_read_b128 v[228:231], v2 offset:512
    ds_read_b128 v[224:227], v2 offset:0
    v_add_u32 v8, v8, v11
    s_nop 6
    v_mul_f32 v219, s55, v219
    v_mul_f32 v220, s55, v220
    v_cvt_pk_bf16_f32 v253, v219, v220
    v_mul_f32 v215, s55, v215
    ds_write_b16 v22, v253
    ds_write_b16_d16_hi v22, v253 offset:64
    v_mul_f32 v216, s55, v216
    v_cvt_pk_bf16_f32 v248, v216, v215
    v_mul_f32 v209, s55, v209
    v_mul_f32 v210, s55, v210
    s_waitcnt lgkmcnt(2)
    v_mfma_f32_16x16x32_bf16 v[232:235], v[228:231], v[44:47], 0
    s_setprio 3
    ds_read2_b32 v[172:173], v6 offset0:16 offset1:17
    ds_read2_b32 v[174:175], v6 offset0:18 offset1:19
    v_cvt_pk_bf16_f32 v249, v210, v209
    v_mul_f32 v211, s55, v211
    v_mfma_f32_16x16x32_bf16 v[236:239], v[228:231], v[48:51], 0
    ds_write_addtid_b32 v248 offset:544
    ds_write_addtid_b32 v248 offset:2724
    v_cvt_pk_bf16_f32 v250, v211, v210
    v_mul_f32 v212, s55, v212
    v_mfma_f32_16x16x32_bf16 v[68:71], v[224:227], v[44:47], 0
    ds_write_addtid_b32 v249 offset:1088
    ds_write_addtid_b32 v249 offset:3268
    v_cvt_pk_bf16_f32 v251, v212, v211
    v_mul_f32 v218, s55, v218
    v_mfma_f32_16x16x32_bf16 v[72:75], v[224:227], v[48:51], 0
    ds_write_addtid_b32 v250 offset:1360
    ds_read2_b32 v[176:177], v6 offset0:32 offset1:33
    v_cvt_pk_bf16_f32 v206, v233, v237
    v_cvt_pk_bf16_f32 v204, v235, v239
    v_mfma_f32_16x16x32_bf16 v[76:79], v[228:231], v[28:31], 0
    ds_read2_b32 v[178:179], v6 offset0:34 offset1:35
    ds_write_addtid_b32 v250 offset:3540
    v_cvt_pk_bf16_f32 v205, v234, v238
    v_cvt_pk_bf16_f32 v207, v232, v236
    s_waitcnt lgkmcnt(6)
    s_nop 0
    v_mfma_f32_16x16x32_bf16 v[60:63], v[204:207], v[172:175], 0
    ds_write_addtid_b32 v251 offset:1632
    ds_read2_b32 v[180:181], v6 offset0:48 offset1:49
    v_mul_f32 v213, s55, v213
    v_mul_f32 v217, s55, v217
    v_mfma_f32_16x16x32_bf16 v[80:83], v[228:231], v[32:35], 0
    ds_read2_b32 v[182:183], v6 offset0:50 offset1:51
    ds_write_addtid_b32 v251 offset:3812
    v_mov_b32 v252, v218
    v_readlane_b32 s38, v248, 63
    v_mfma_f32_16x16x32_bf16 v[232:235], v[228:231], v[36:39], 0
    ds_read_b128 v[224:227], v2 offset:1024
    ds_read2_b32 v[168:169], v6 offset0:0 offset1:1
    v_cvt_pk_bf16_f32 v192, v71, v75
    v_cvt_pk_bf16_f32 v193, v70, v74
    v_mfma_f32_16x16x32_bf16 v[236:239], v[228:231], v[40:43], 0
    ds_read2_b32 v[170:171], v6 offset0:2 offset1:3
    v_cvt_pk_bf16_f32 v248, v213, v212
    v_cvt_pk_bf16_f32 v194, v69, v73
    ds_write_addtid_b32 v248 offset:1904
    ds_write_addtid_b32 v248 offset:4084
    v_cvt_pk_bf16_f32 v195, v68, v72
    v_mov_b32_dpp v252, v217 wave_shl:1 row_mask:0xf bank_mask:0xf
    v_cvt_pk_bf16_f32 v252, v218, v252
    v_mul_f32 v214, s55, v214
    v_mfma_f32_16x16x32_bf16 v[56:59], v[192:195], v[172:175], 0
    s_setprio 2
    ds_write_addtid_b32 v252 offset:14808
    ds_write_addtid_b32 v252 offset:15184
    v_cvt_pk_bf16_f32 v249, v214, v213
    v_cvt_pk_bf16_f32 v250, v215, v214
    s_waitcnt lgkmcnt(5)
    v_mfma_f32_16x16x32_bf16 v[60:63], v[192:195], v[176:179], v[60:63]
    ds_write_addtid_b32 v249 offset:2176
    ds_write_addtid_b32 v249 offset:4356
    v_fma_f32 v208, s55, v208, v19
    v_cvt_pk_bf16_f32 v251, v209, v208
    v_mfma_f32_16x16x32_bf16 v[64:67], v[192:195], v[180:183], 0
    ds_write_addtid_b32 v250 offset:272
    ds_write_addtid_b32 v250 offset:2452
    v_cvt_pk_bf16_f32 v196, v79, v83
    v_cvt_pk_bf16_f32 v198, v78, v82
    v_mfma_f32_16x16x32_bf16 v[68:71], v[224:227], v[28:31], 0
    ds_write_addtid_b32 v251 offset:816
    ds_write_addtid_b32 v251 offset:2996
    s_mov_b32 m0, s50
    v_cvt_pk_bf16_f32 v200, v77, v81
    v_cvt_pk_bf16_f32 v202, v76, v80
    v_mfma_f32_16x16x32_bf16 v[72:75], v[224:227], v[32:35], 0
    ds_read_b128 v[160:163], v5 offset:256
    ds_read_b128 v[164:167], v5 offset:272
    v_cvt_pk_bf16_f32 v197, v235, v239
    v_cvt_pk_bf16_f32 v199, v234, v238
    v_mfma_f32_16x16x32_bf16 v[76:79], v[224:227], v[36:39], 0
    ds_read_b128 v[152:155], v5 offset:128
    ds_read_b128 v[156:159], v5 offset:144
    v_cvt_pk_bf16_f32 v201, v233, v237
    v_cvt_pk_bf16_f32 v203, v232, v236
    v_mfma_f32_16x16x32_bf16 v[80:83], v[224:227], v[40:43], 0
    ds_read_b128 v[144:147], v5 offset:0
    ds_read_b128 v[148:151], v5 offset:16
    v_cvt_pk_bf16_f32 v254, -v218, v10
    s_nop 0
    v_readlane_b32 s57, v254, 63
    v_mfma_f32_16x16x32_bf16 v[232:235], v[224:227], v[44:47], 0
    ds_read_b64 v[136:137], v3 offset:240
    ds_read_b64 v[138:139], v4 offset:240
    v_mul_u32_u24 v52, s57, v52
    v_mul_u32_u24 v53, s57, v53
    v_mfma_f32_16x16x32_bf16 v[236:239], v[224:227], v[48:51], 0
    s_setprio 1
    ds_read_b64 v[132:133], v3 offset:224
    ds_read_b64 v[134:135], v4 offset:224
    v_mul_u32_u24 v54, s57, v54
    v_mul_u32_u24 v55, s57, v55
    s_waitcnt lgkmcnt(6)
    v_mfma_f32_16x16x32_bf16 v[56:59], v[204:207], v[168:171], v[56:59]
    ds_read_b64 v[128:129], v3 offset:208
    v_cvt_pk_bf16_f32 v255, v208, v217
    s_nop 0
    v_readlane_b32 s39, v255, 0
    v_mfma_f32_16x16x32_bf16 v[56:59], v[52:55], v[228:231], v[56:59]
    ds_read_b128 v[228:231], v2 offset:1536
    ds_read_b64 v[130:131], v4 offset:208
    v_mov_b32 v255, s38
    v_perm_b32 v255, v255, s39, v21
    v_mfma_f32_16x16x32_bf16 v[56:59], v[196:199], v[160:163], v[56:59]
    ds_write_b32 v20, v255
    v_cvt_pk_bf16_f32 v184, v71, v75
    v_mfma_f32_16x16x32_bf16 v[56:59], v[200:203], v[164:167], v[56:59]
    ds_read_b64 v[140:141], v3 offset:256
    ds_read_b64 v[142:143], v4 offset:256
    v_cvt_pk_bf16_f32 v186, v70, v74
    v_cvt_pk_bf16_f32 v188, v69, v73
    v_mfma_f32_16x16x32_bf16 v[60:63], v[52:55], v[224:227], v[60:63]
    ds_read_b64 v[124:125], v3 offset:192
    ds_read_b64 v[126:127], v4 offset:192
    v_cvt_pk_bf16_f32 v190, v68, v72
    v_cvt_pk_bf16_f32 v189, v77, v81
    s_waitcnt lgkmcnt(5)
    v_mfma_f32_16x16x32_bf16 v[68:71], v[228:231], v[36:39], 0
    ds_read_b64 v[104:105], v3 offset:112
    v_cvt_pk_bf16_f32 v191, v76, v80
    v_cvt_pk_bf16_f32 v185, v79, v83
    v_mfma_f32_16x16x32_bf16 v[72:75], v[228:231], v[40:43], 0
    ds_read_b64 v[76:77], v3 offset:0
    v_cvt_pk_bf16_f32 v187, v78, v82
    v_cvt_pk_bf16_f32 v192, v235, v239
    v_mfma_f32_16x16x32_bf16 v[64:67], v[204:207], v[176:179], v[64:67]
    ds_read_b64 v[78:79], v4 offset:0
    s_waitcnt vmcnt(0)
    v_perm_b32 v24, v244, v240, v0
    v_perm_b32 v25, v244, v240, v7
    v_mfma_f32_16x16x32_bf16 v[56:59], v[184:187], v[152:155], v[56:59]
    s_setprio 0
    ds_write_addtid_b32 v24 offset:0
    ds_write_addtid_b32 v25 offset:4160
    v_perm_b32 v26, v245, v241, v0
    v_perm_b32 v27, v245, v241, v7
    v_mfma_f32_16x16x32_bf16 v[56:59], v[188:191], v[156:159], v[56:59]
    ds_write_addtid_b32 v26 offset:8320
    ds_write_addtid_b32 v27 offset:12480
    v_perm_b32 v24, v246, v242, v0
    v_perm_b32 v25, v246, v242, v7
    v_mfma_f32_16x16x32_bf16 v[60:63], v[184:187], v[160:163], v[60:63]
    ds_write_addtid_b32 v24 offset:16640
    ds_write_addtid_b32 v25 offset:20800
    v_perm_b32 v26, v247, v243, v0
    v_perm_b32 v27, v247, v243, v7
    v_mfma_f32_16x16x32_bf16 v[240:243], v[228:231], v[28:31], 0
    ds_write_addtid_b32 v26 offset:24960
    ds_write_addtid_b32 v27 offset:29120
    s_mov_b32 m0, s35
    v_cvt_pk_bf16_f32 v193, v234, v238
    v_mfma_f32_16x16x32_bf16 v[244:247], v[228:231], v[32:35], 0
    ds_read_b64 v[106:107], v4 offset:112
    ds_read_b64 v[116:117], v3 offset:160
    v_cvt_pk_bf16_f32 v194, v233, v237
    v_cvt_pk_bf16_f32 v195, v232, v236
    v_mfma_f32_16x16x32_bf16 v[60:63], v[188:191], v[164:167], v[60:63]
    ds_read_b64 v[118:119], v4 offset:160
    v_cvt_pk_bf16_f32 v197, v71, v75
    v_cvt_pk_bf16_f32 v199, v70, v74
    v_mfma_f32_16x16x32_bf16 v[60:63], v[192:195], v[168:171], v[60:63]
    ds_read_b64 v[120:121], v3 offset:176
    v_cvt_pk_bf16_f32 v196, v243, v247
    v_cvt_pk_bf16_f32 v198, v242, v246
    s_nop 1
    v_mfma_f32_16x16x32_bf16 v[56:59], v[196:199], v[144:147], v[56:59]
    s_waitcnt lgkmcnt(4)
    s_barrier
    ds_read_b128 v[12:15], v2 offset:1568
    ds_read_b128 v[16:19], v2 offset:1632
    v_cvt_pk_bf16_f32 v200, v241, v245
    v_cvt_pk_bf16_f32 v202, v240, v244
    v_mfma_f32_16x16x32_bf16 v[60:63], v[196:199], v[152:155], v[60:63]
    s_setprio 3
    ds_read_b128 v[212:215], v2 offset:1696
    ds_read_b128 v[208:211], v2 offset:1760
    v_cvt_pk_bf16_f32 v201, v69, v73
    v_cvt_pk_bf16_f32 v203, v68, v72
    s_nop 1
    v_mfma_f32_16x16x32_bf16 v[56:59], v[200:203], v[148:151], v[56:59]
    ds_read_b128 v[220:223], v2 offset:1824
    ds_read_b128 v[216:219], v2 offset:2592
    v_mfma_f32_16x16x32_bf16 v[60:63], v[200:203], v[156:159], v[60:63]
    ds_read_b128 v[20:23], v2 offset:2144
    ds_read_b64 v[122:123], v4 offset:176
    s_waitcnt lgkmcnt(6)
    v_mfma_f32_16x16x32_bf16 v[56:59], v[140:143], v[12:15], v[56:59]
    ds_read_b128 v[12:15], v2 offset:1952
    ds_read_b64 v[112:113], v3 offset:144
    v_mfma_f32_16x16x32_bf16 v[56:59], v[136:139], v[16:19], v[56:59]
    ds_read_b128 v[16:19], v2 offset:1888
    ds_read_b64 v[114:115], v4 offset:144
    s_waitcnt lgkmcnt(6)
    v_mfma_f32_16x16x32_bf16 v[56:59], v[132:135], v[212:215], v[56:59]
    ds_read_b128 v[212:215], v2 offset:2016
    ds_read_b64 v[108:109], v3 offset:128
    v_mfma_f32_16x16x32_bf16 v[56:59], v[128:131], v[208:211], v[56:59]
    ds_read_b64 v[110:111], v4 offset:128
    v_mfma_f32_16x16x32_bf16 v[56:59], v[124:127], v[220:223], v[56:59]
    ds_read_b128 v[208:211], v2 offset:2080
    v_mfma_f32_16x16x32_bf16 v[56:59], v[76:79], v[216:219], v[56:59]
    ds_read_b64 v[100:101], v3 offset:96
    s_waitcnt lgkmcnt(3)
    v_mfma_f32_16x16x32_bf16 v[56:59], v[104:107], v[20:23], v[56:59]
    ds_read_b64 v[102:103], v4 offset:96
    v_mfma_f32_16x16x32_bf16 v[60:63], v[136:139], v[20:23], v[60:63]
    s_setprio 2
    ds_read_b128 v[220:223], v2 offset:2208
    v_mfma_f32_16x16x32_bf16 v[56:59], v[116:119], v[12:15], v[56:59]
    ds_read_b128 v[224:227], v2 offset:2048
    v_mfma_f32_16x16x32_bf16 v[56:59], v[120:123], v[16:19], v[56:59]
    ds_read_b64 v[96:97], v3 offset:80
    v_mfma_f32_16x16x32_bf16 v[56:59], v[112:115], v[212:215], v[56:59]
    ds_read_b64 v[98:99], v4 offset:80
    v_mfma_f32_16x16x32_bf16 v[64:67], v[192:195], v[172:175], v[64:67]
    ds_read_b128 v[216:219], v2 offset:2272
    s_waitcnt lgkmcnt(3)
    v_mfma_f32_16x16x32_bf16 v[56:59], v[108:111], v[208:211], v[56:59]
    ds_read_b64 v[92:93], v3 offset:64
    v_mfma_f32_16x16x32_bf16 v[60:63], v[140:143], v[208:211], v[60:63]
    ds_read_b64 v[94:95], v4 offset:64
    v_mfma_f32_16x16x32_bf16 v[56:59], v[100:103], v[220:223], v[56:59]
    ds_read_b128 v[20:23], v2 offset:2336
    v_mfma_f32_16x16x32_bf16 v[60:63], v[132:135], v[220:223], v[60:63]
    ds_read_b64 v[88:89], v3 offset:48
    v_mfma_f32_16x16x32_bf16 v[232:235], v[224:227], v[28:31], 0
    s_setprio 1
    ds_read_b64 v[90:91], v4 offset:48
    v_mfma_f32_16x16x32_bf16 v[236:239], v[224:227], v[32:35], 0
    ds_read_b128 v[12:15], v2 offset:2400
    v_mfma_f32_16x16x32_bf16 v[240:243], v[224:227], v[36:39], 0
    ds_read_b64 v[84:85], v3 offset:32
    v_mfma_f32_16x16x32_bf16 v[244:247], v[224:227], v[40:43], 0
    ds_read_b64 v[86:87], v4 offset:32
    s_nop 2
    v_cvt_pk_bf16_f32 v184, v235, v239
    v_cvt_pk_bf16_f32 v186, v234, v238
    s_waitcnt lgkmcnt(3)
    v_mfma_f32_16x16x32_bf16 v[56:59], v[96:99], v[216:219], v[56:59]
    ds_read_b128 v[16:19], v2 offset:2464
    v_cvt_pk_bf16_f32 v188, v233, v237
    v_cvt_pk_bf16_f32 v190, v232, v236
    v_mfma_f32_16x16x32_bf16 v[60:63], v[128:131], v[216:219], v[60:63]
    ds_read_b64 v[80:81], v3 offset:16
    v_cvt_pk_bf16_f32 v185, v243, v247
    v_cvt_pk_bf16_f32 v187, v242, v246
    v_mfma_f32_16x16x32_bf16 v[56:59], v[92:95], v[20:23], v[56:59]
    ds_read_b64 v[82:83], v4 offset:16
    v_cvt_pk_bf16_f32 v189, v241, v245
    v_cvt_pk_bf16_f32 v191, v240, v244
    v_mfma_f32_16x16x32_bf16 v[60:63], v[124:127], v[20:23], v[60:63]
    ds_read_b128 v[212:215], v2 offset:2528
    s_waitcnt lgkmcnt(3)
    v_mfma_f32_16x16x32_bf16 v[56:59], v[88:91], v[12:15], v[56:59]
    ds_read_b128 v[208:211], v2 offset:2592
    v_mfma_f32_16x16x32_bf16 v[56:59], v[84:87], v[16:19], v[56:59]
    s_setprio 0
    ds_read_b128 v[220:223], v2 offset:2400
    v_mfma_f32_16x16x32_bf16 v[64:67], v[196:199], v[160:163], v[64:67]
    ds_read_b128 v[216:219], v2 offset:2528
    s_waitcnt lgkmcnt(3)
    v_mfma_f32_16x16x32_bf16 v[56:59], v[80:83], v[212:215], v[56:59]
    ds_read_b128 v[20:23], v2 offset:2656
    v_mfma_f32_16x16x32_bf16 v[64:67], v[200:203], v[164:167], v[64:67]
    ds_read_b128 v[12:15], v2 offset:2720
    s_nop 4
    v_cvt_pk_bf16_f32 v24, v56, v57
    v_cvt_pk_bf16_f32 v25, v58, v59
    s_waitcnt lgkmcnt(3)
    v_mfma_f32_16x16x32_bf16 v[60:63], v[108:111], v[208:211], v[60:63]
    ds_write_addtid_b32 v24 offset:4896
    ds_write_addtid_b32 v25 offset:5152
    v_mfma_f32_16x16x32_bf16 v[60:63], v[120:123], v[220:223], v[60:63]
    ds_read_b128 v[16:19], v2 offset:2784
    s_waitcnt lgkmcnt(4)
    v_mfma_f32_16x16x32_bf16 v[60:63], v[112:115], v[216:219], v[60:63]
    ds_read_b128 v[212:215], v2 offset:2848
    v_mfma_f32_16x16x32_bf16 v[60:63], v[184:187], v[144:147], v[60:63]
    ds_read_b128 v[208:211], v2 offset:2976
    v_mfma_f32_16x16x32_bf16 v[60:63], v[188:191], v[148:151], v[60:63]
    s_waitcnt lgkmcnt(3)
    s_barrier
    ds_read_b64_tr_b16 v[248:249], v8 offset:0
    v_mfma_f32_16x16x32_bf16 v[60:63], v[104:107], v[20:23], v[60:63]
    s_setprio 3
    ds_read_b128 v[220:223], v2 offset:3040
    v_mfma_f32_16x16x32_bf16 v[60:63], v[100:103], v[12:15], v[60:63]
    ds_read_b128 v[216:219], v2 offset:2464
    v_mfma_f32_16x16x32_bf16 v[64:67], v[132:135], v[12:15], v[64:67]
    ds_read_b128 v[20:23], v2 offset:2912
    s_waitcnt lgkmcnt(3)
    v_mfma_f32_16x16x32_bf16 v[60:63], v[96:99], v[16:19], v[60:63]
    buffer_store_dwordx2 v[248:249], v9, s[28:31], s56 offen
    s_mov_b32 s56, 3145728
    v_mfma_f32_16x16x32_bf16 v[64:67], v[128:131], v[16:19], v[64:67]
    v_mfma_f32_16x16x32_bf16 v[60:63], v[92:95], v[212:215], v[60:63]
    s_setprio 2
    ds_read_b128 v[12:15], v2 offset:3104
    v_mfma_f32_16x16x32_bf16 v[60:63], v[84:87], v[208:211], v[60:63]
    ds_read_b128 v[16:19], v2 offset:2912
    v_mfma_f32_16x16x32_bf16 v[64:67], v[116:119], v[208:211], v[64:67]
    ds_read_b128 v[212:215], v2 offset:3040
    s_waitcnt lgkmcnt(3)
    v_mfma_f32_16x16x32_bf16 v[60:63], v[80:83], v[220:223], v[60:63]
    ds_read_b128 v[208:211], v2 offset:2592
    v_mfma_f32_16x16x32_bf16 v[60:63], v[116:119], v[216:219], v[60:63]
    ds_read_b128 v[220:223], v2 offset:2848
    v_mfma_f32_16x16x32_bf16 v[60:63], v[88:91], v[20:23], v[60:63]
    s_setprio 1
    ds_read_b128 v[216:219], v2 offset:2656
    s_waitcnt lgkmcnt(3)
    v_mfma_f32_16x16x32_bf16 v[60:63], v[76:79], v[12:15], v[60:63]
    ds_read_b128 v[20:23], v2 offset:3168
    v_mfma_f32_16x16x32_bf16 v[64:67], v[108:111], v[12:15], v[64:67]
    ds_read_b128 v[224:227], v2 offset:2560
    s_nop 4
    v_cvt_pk_bf16_f32 v26, v60, v61
    v_cvt_pk_bf16_f32 v27, v62, v63
    v_mfma_f32_16x16x32_bf16 v[64:67], v[120:123], v[16:19], v[64:67]
    ds_write_addtid_b32 v26 offset:5408
    v_mfma_f32_16x16x32_bf16 v[64:67], v[112:115], v[212:215], v[64:67]
    ds_write_addtid_b32 v27 offset:5664
    s_waitcnt lgkmcnt(3)
    v_mfma_f32_16x16x32_bf16 v[64:67], v[140:143], v[208:211], v[64:67]
    s_setprio 0
    ds_read_b128 v[12:15], v2 offset:3232
    v_mfma_f32_16x16x32_bf16 v[64:67], v[124:127], v[220:223], v[64:67]
    ds_read_b128 v[16:19], v2 offset:3296
    v_mfma_f32_16x16x32_bf16 v[64:67], v[136:139], v[216:219], v[64:67]
    ds_read_b128 v[212:215], v2 offset:3360
    v_mfma_f32_16x16x32_bf16 v[64:67], v[104:107], v[20:23], v[64:67]
    s_waitcnt lgkmcnt(3)
    s_barrier
    ds_read_b64_tr_b16 v[252:253], v8 offset:512
    v_mfma_f32_16x16x32_bf16 v[68:71], v[224:227], v[28:31], 0
    s_setprio 3
    ds_read_b128 v[208:211], v2 offset:3424
    v_mfma_f32_16x16x32_bf16 v[72:75], v[224:227], v[32:35], 0
    ds_read_b128 v[220:223], v2 offset:3488
    v_mfma_f32_16x16x32_bf16 v[232:235], v[224:227], v[36:39], 0
    ds_read_b128 v[216:219], v2 offset:3552
    v_mfma_f32_16x16x32_bf16 v[236:239], v[224:227], v[40:43], 0
    s_waitcnt lgkmcnt(3)
    buffer_store_dwordx2 v[252:253], v9, s[28:31], s56 offen
    s_mov_b32 s56, 3670016
    s_nop 0
    v_cvt_pk_bf16_f32 v196, v71, v75
    v_mfma_f32_16x16x32_bf16 v[64:67], v[100:103], v[12:15], v[64:67]
    v_cvt_pk_bf16_f32 v198, v70, v74
    v_cvt_pk_bf16_f32 v200, v69, v73
    v_mfma_f32_16x16x32_bf16 v[240:243], v[228:231], v[44:47], 0
    s_setprio 2
    ds_read_b128 v[20:23], v2 offset:3616
    v_cvt_pk_bf16_f32 v197, v235, v239
    v_cvt_pk_bf16_f32 v199, v234, v238
    v_mfma_f32_16x16x32_bf16 v[244:247], v[228:231], v[48:51], 0
    v_cvt_pk_bf16_f32 v202, v68, v72
    v_cvt_pk_bf16_f32 v201, v233, v237
    v_mfma_f32_16x16x32_bf16 v[64:67], v[52:55], v[228:231], v[64:67]
    v_cvt_pk_bf16_f32 v203, v232, v236
    v_mfma_f32_16x16x32_bf16 v[64:67], v[96:99], v[16:19], v[64:67]
    s_nop 2
    v_cvt_pk_bf16_f32 v204, v243, v247
    v_cvt_pk_bf16_f32 v205, v242, v246
    v_mfma_f32_16x16x32_bf16 v[64:67], v[92:95], v[212:215], v[64:67]
    v_cvt_pk_bf16_f32 v206, v241, v245
    v_cvt_pk_bf16_f32 v207, v240, v244
    v_mfma_f32_16x16x32_bf16 v[64:67], v[196:199], v[144:147], v[64:67]
    s_setprio 1
    v_mfma_f32_16x16x32_bf16 v[64:67], v[200:203], v[148:151], v[64:67]
    s_waitcnt lgkmcnt(0)
    v_mfma_f32_16x16x32_bf16 v[64:67], v[88:91], v[208:211], v[64:67]
    v_mfma_f32_16x16x32_bf16 v[64:67], v[84:87], v[220:223], v[64:67]
    v_mfma_f32_16x16x32_bf16 v[64:67], v[184:187], v[152:155], v[64:67]
    v_mfma_f32_16x16x32_bf16 v[64:67], v[188:191], v[156:159], v[64:67]
    s_setprio 0
    v_mfma_f32_16x16x32_bf16 v[64:67], v[204:207], v[168:171], v[64:67]
    v_mfma_f32_16x16x32_bf16 v[64:67], v[80:83], v[216:219], v[64:67]
    v_mfma_f32_16x16x32_bf16 v[64:67], v[76:79], v[20:23], v[64:67]
    s_nop 7
    v_cvt_pk_bf16_f32 v24, v64, v65
    v_cvt_pk_bf16_f32 v25, v66, v67
    ds_write_addtid_b32 v24 offset:5920
    ds_write_addtid_b32 v25 offset:6176
    s_waitcnt lgkmcnt(0)
    s_barrier
    ds_read_b64_tr_b16 v[248:249], v8 offset:1024
    s_waitcnt lgkmcnt(0)
    buffer_store_dwordx2 v[248:249], v9, s[28:31], s56 offen
    s_endpgm
L_end:
    s_endpgm
.p2align 7
L_tbl:
.long 0x00000000, 0x00000000, 0x3f800000, 0x00000000, 0x00000000, 0x00000000, 0x00000000, 0x00000000
.long 0x00000000, 0x00000000, 0x00000000, 0x00000000, 0x00000000, 0x00000000, 0x00000000, 0x00000000
.long 0x00000000, 0x00000000, 0x00000000, 0x00000000, 0x00000000, 0x00000000, 0x00000000, 0x00000000
.long 0x00000000, 0x00000000, 0x00000000, 0x00000000, 0x00000000, 0x00000000, 0x00000000, 0x00000000
.long 0x00000000, 0x00000000, 0x00000000, 0x00000000, 0x00000000, 0x00000000, 0x00000000, 0x00000000
.long 0x00000000, 0x00000000, 0x00000000, 0x00000000, 0x00000000, 0x00000000, 0x00000000, 0x00000000
.long 0x00000000, 0x00000000, 0x00000000, 0x00000000, 0x00000000, 0x00000000, 0x00000000, 0x00000000
.long 0x00000000, 0x00000000, 0x00000000, 0x00000000, 0x00000000, 0x00000000, 0x00000000, 0x00000000
.long 0x3f803f80, 0x00000000, 0x3f803f80, 0x00000000, 0x3f803f80, 0x00000000, 0x3f803f80, 0x00000000
.long 0x3f800000, 0x00000000, 0x3f803f80, 0x00000000, 0x00000000, 0x00000000, 0x3f803f80, 0x00000000
.long 0x00000000, 0x00000000, 0x3f800000, 0x00000000, 0x00000000, 0x00000000, 0x00000000, 0x00000000
.long 0x00000000, 0x00000000, 0x00000000, 0x00000000, 0x00000000, 0x00000000, 0x00000000, 0x00000000
.long 0x00000000, 0x00000000, 0x00000000, 0x00000000, 0x00000000, 0x00000000, 0x00000000, 0x00000000
.long 0x00000000, 0x00000000, 0x00000000, 0x00000000, 0x00000000, 0x00000000, 0x00000000, 0x00000000
.long 0x00000000, 0x00000000, 0x00000000, 0x00000000, 0x00000000, 0x00000000, 0x00000000, 0x00000000
.long 0x00000000, 0x00000000, 0x00000000, 0x00000000, 0x00000000, 0x00000000, 0x00000000, 0x00000000
.long 0x00000000, 0x00000000, 0x00000000, 0x00000000, 0x00000000, 0x00003f80, 0x00000000, 0x00000000
.long 0x00000000, 0x3f803f80, 0x00000000, 0x00000000, 0x00000000, 0x3f803f80, 0x00000000, 0x00003f80
.long 0x00000000, 0x3f803f80, 0x00000000, 0x3f803f80, 0x00000000, 0x3f803f80, 0x00000000, 0x3f803f80
.long 0x00000000, 0x3f800000, 0x00000000, 0x3f803f80, 0x00000000, 0x00000000, 0x00000000, 0x3f803f80
.long 0x00000000, 0x00000000, 0x00000000, 0x3f800000, 0x00003f80, 0x00000000, 0x00000000, 0x00000000
.long 0x3f803f80, 0x00000000, 0x00000000, 0x00000000, 0x3f803f80, 0x00000000, 0x00003f80, 0x00000000
.long 0x3f803f80, 0x00000000, 0x3f803f80, 0x00000000, 0x3f803f80, 0x00000000, 0x3f803f80, 0x00000000
.long 0x3f800000, 0x00000000, 0x3f803f80, 0x00000000, 0x00000000, 0x00000000, 0x3f803f80, 0x00000000
.long 0x00000000, 0x00000000, 0x00000000, 0x00000000, 0x00000000, 0x00000000, 0x00000000, 0x00000000
.long 0x00000000, 0x00000000, 0x00000000, 0x00000000, 0x00000000, 0x00000000, 0x00000000, 0x00000000
.long 0x00000000, 0x00000000, 0x00000000, 0x00000000, 0x00000000, 0x00003f80, 0x00000000, 0x00000000
.long 0x00000000, 0x3f803f80, 0x00000000, 0x00000000, 0x00000000, 0x3f803f80, 0x00000000, 0x00003f80
.long 0x00000000, 0x3f803f80, 0x00000000, 0x3f803f80, 0x00000000, 0x3f803f80, 0x00000000, 0x3f803f80
.long 0x00000000, 0x3f800000, 0x00000000, 0x3f803f80, 0x00000000, 0x00000000, 0x00000000, 0x3f803f80
.long 0x00000000, 0x00000000, 0x00000000, 0x3f800000, 0x00003f80, 0x00000000, 0x00000000, 0x00000000
.long 0x3f803f80, 0x00000000, 0x00000000, 0x00000000, 0x3f803f80, 0x00000000, 0x00003f80, 0x00000000
.long 0x3f803f80, 0x00000000, 0x00003f80, 0x00000000, 0x3f800000, 0x00000000, 0x3f803f80, 0x00000000
.long 0x00000000, 0x00000000, 0x3f803f80, 0x00000000, 0x00000000, 0x00000000, 0x3f800000, 0x00000000
.long 0x00000000, 0x00000000, 0x00000000, 0x00000000, 0x00000000, 0x00000000, 0x00000000, 0x00000000
.long 0x00000000, 0x00000000, 0x00000000, 0x00000000, 0x00000000, 0x00000000, 0x00000000, 0x00000000
.long 0x00000000, 0x00000000, 0x00000000, 0x00000000, 0x00000000, 0x00000000, 0x00000000, 0x00000000
.long 0x00000000, 0x00000000, 0x00000000, 0x00000000, 0x00000000, 0x00000000, 0x00000000, 0x00000000
.long 0x00000000, 0x00000000, 0x00000000, 0x00000000, 0x00000000, 0x00000000, 0x00000000, 0x00000000
.long 0x00000000, 0x00000000, 0x00000000, 0x00000000, 0x00000000, 0x00000000, 0x00000000, 0x00000000
.long 0x00000000, 0x00000000, 0x00000000, 0x00000000, 0x00000000, 0x00000000, 0x00000000, 0x00000000
.long 0x00003f80, 0x00000000, 0x00000000, 0x00000000, 0x3f803f80, 0x00000000, 0x00000000, 0x00000000
.long 0x3f803f80, 0x00000000, 0x00003f80, 0x00000000, 0x3f800000, 0x00000000, 0x3f803f80, 0x00000000
.long 0x00000000, 0x00000000, 0x3f803f80, 0x00000000, 0x00000000, 0x00000000, 0x3f800000, 0x00000000
.long 0x00000000, 0x00000000, 0x00000000, 0x00000000, 0x00000000, 0x00000000, 0x00000000, 0x00000000
.long 0x00000000, 0x00000000, 0x00000000, 0x00000000, 0x00000000, 0x00000000, 0x00000000, 0x00000000
.long 0x00000000, 0x00000000, 0x00000000, 0x00000000, 0x00000000, 0x00000000, 0x00000000, 0x00000000
.long 0x00000000, 0x00000000, 0x00000000, 0x00000000, 0x00000000, 0x00000000, 0x00000000, 0x00000000
.long 0x00000000, 0x00000000, 0x00000000, 0x00000000, 0x00000000, 0x00000000, 0x00000000, 0x00000000
.long 0x00000000, 0x00000000, 0x00000000, 0x00000000, 0x00000000, 0x00000000, 0x00000000, 0x00000000
.long 0x00000000, 0x00000000, 0x00000000, 0x00000000, 0x00000000, 0x00000000, 0x00000000, 0x00000000
.long 0x00000000, 0x00003f80, 0x00000000, 0x00000000, 0x00000000, 0x3f803f80, 0x00000000, 0x00000000
.long 0x00000000, 0x3f803f80, 0x00000000, 0x00003f80, 0x00000000, 0x3f800000, 0x00000000, 0x3f803f80
.long 0x00000000, 0x00000000, 0x00000000, 0x3f803f80, 0x00000000, 0x00000000, 0x00000000, 0x3f800000
.long 0x00000000, 0x00000000, 0x00000000, 0x00000000, 0x00000000, 0x00000000, 0x00000000, 0x00000000
.long 0x00003f80, 0x00000000, 0x00000000, 0x00000000, 0x3f803f80, 0x00000000, 0x00000000, 0x00000000
.long 0x00000000, 0x00000000, 0x00000000, 0x00000000, 0x00000000, 0x00000000, 0x00000000, 0x00000000
.long 0x00000000, 0x00000000, 0x00000000, 0x00000000, 0x00000000, 0x00000000, 0x00000000, 0x00000000
.long 0x00000000, 0x00000000, 0x00000000, 0x00000000, 0x00000000, 0x00000000, 0x00000000, 0x00000000
.long 0x00000000, 0x00000000, 0x00000000, 0x00000000, 0x00000000, 0x00000000, 0x00000000, 0x00000000
.long 0x00000000, 0x00000000, 0x00000000, 0x00000000, 0x00000000, 0x00000000, 0x00000000, 0x00000000
.long 0x00000000, 0x00003f80, 0x00000000, 0x00000000, 0x00000000, 0x3f803f80, 0x00000000, 0x00000000
.long 0x00000000, 0x3f803f80, 0x00000000, 0x00003f80, 0x00000000, 0x3f800000, 0x00000000, 0x3f803f80
.long 0x00000000, 0x00000000, 0x00000000, 0x3f803f80, 0x00000000, 0x00000000, 0x00000000, 0x3f800000
.long 0x00000000, 0x00000000, 0x00000000, 0x3f800000, 0x00003f80, 0x00000000, 0x00000000, 0x00000000
.long 0x3f803f80, 0x00000000, 0x00000000, 0x00000000, 0x3f803f80, 0x00000000, 0x00003f80, 0x00000000
.long 0x3f803f80, 0x00000000, 0x3f803f80, 0x00000000, 0x3f803f80, 0x00000000, 0x3f803f80, 0x00000000
.long 0x3f800000, 0x00000000, 0x3f803f80, 0x00000000, 0x00000000, 0x00000000, 0x3f803f80, 0x00000000
.long 0x00000000, 0x00000000, 0x3f800000, 0x00000000, 0x00000000, 0x00000000, 0x00000000, 0x00000000
.long 0x00000000, 0x00000000, 0x00000000, 0x00000000, 0x00000000, 0x00000000, 0x00000000, 0x00000000
.long 0x00000000, 0x00000000, 0x00000000, 0x00000000, 0x00000000, 0x00000000, 0x00000000, 0x00000000
.long 0x00000000, 0x00000000, 0x00000000, 0x00000000, 0x00000000, 0x00000000, 0x00000000, 0x00000000
.long 0x00000000, 0x3f803f80, 0x00000000, 0x3f803f80, 0x00000000, 0x3f803f80, 0x00000000, 0x3f803f80
.long 0x00000000, 0x3f800000, 0x00000000, 0x3f803f80, 0x00000000, 0x00000000, 0x00000000, 0x3f803f80
.long 0x00000000, 0x00000000, 0x00000000, 0x3f800000, 0x00003f80, 0x00000000, 0x00000000, 0x00000000
.long 0x3f803f80, 0x00000000, 0x00000000, 0x00000000, 0x3f803f80, 0x00000000, 0x00003f80, 0x00000000
.long 0x3f803f80, 0x00000000, 0x3f803f80, 0x00000000, 0x3f803f80, 0x00000000, 0x3f803f80, 0x00000000
.long 0x3f800000, 0x00000000, 0x3f803f80, 0x00000000, 0x00000000, 0x00000000, 0x3f803f80, 0x00000000
.long 0x00000000, 0x00000000, 0x3f800000, 0x00000000, 0x00000000, 0x00000000, 0x00000000, 0x00000000
.long 0x00000000, 0x00000000, 0x00000000, 0x00000000, 0x00000000, 0x00000000, 0x00000000, 0x00000000
.long 0x00000000, 0x00000000, 0x00000000, 0x00000000, 0x00000000, 0x00000000, 0x00000000, 0x00000000
.long 0x00000000, 0x00000000, 0x00000000, 0x00000000, 0x00000000, 0x00000000, 0x00000000, 0x00000000
.long 0x00000000, 0x00000000, 0x00000000, 0x00000000, 0x00000000, 0x00000000, 0x00000000, 0x00000000
.long 0x00000000, 0x00000000, 0x00000000, 0x00000000, 0x00000000, 0x00000000, 0x00000000, 0x00000000
.long 0x00000000, 0x00000000, 0x00000000, 0x00000000, 0x00000000, 0x00003f80, 0x00000000, 0x00000000
.long 0x00000000, 0x3f803f80, 0x00000000, 0x00000000, 0x00000000, 0x3f803f80, 0x00000000, 0x00003f80
.long 0x00000000, 0x3f803f80, 0x00000000, 0x3f803f80, 0x00000000, 0x3f803f80, 0x00000000, 0x3f803f80
.long 0x00000000, 0x3f800000, 0x00000000, 0x3f803f80, 0x00000000, 0x00000000, 0x00000000, 0x3f803f80
.long 0x00000000, 0x00000000, 0x00000000, 0x00000000, 0x00000000, 0x00000000, 0x00000000, 0x00000000
.long 0x00000000, 0x00000000, 0x00000000, 0x00000000, 0x00000000, 0x00000000, 0x00000000, 0x00000000
.long 0x00000000, 0x00000000, 0x00000000, 0x00000000, 0x00000000, 0x00000000, 0x00000000, 0x00000000
.long 0x00000000, 0x00000000, 0x00000000, 0x00000000, 0x00000000, 0x00000000, 0x00000000, 0x00000000
.long 0x00000000, 0x00000000, 0x00000000, 0x00000000, 0x00000000, 0x00000000, 0x00000000, 0x00000000
.long 0x00000000, 0x00000000, 0x00000000, 0x00000000, 0x00000000, 0x00000000, 0x00000000, 0x00000000
.long 0x00000000, 0x00000000, 0x00000000, 0x00000000, 0x00000000, 0x00003f80, 0x00000000, 0x00000000
.long 0x00000000, 0x3f803f80, 0x00000000, 0x00000000, 0x00000000, 0x3f803f80, 0x00000000, 0x00003f80
.long 0x00000000, 0x3f803f80, 0x00000000, 0x00003f80, 0x00000000, 0x3f800000, 0x00000000, 0x3f803f80
.long 0x00000000, 0x00000000, 0x00000000, 0x3f803f80, 0x00000000, 0x00000000, 0x00000000, 0x3f800000
.long 0x00000000, 0x00000000, 0x00000000, 0x00000000, 0x00000000, 0x00000000, 0x00000000, 0x00000000
.long 0x00003f80, 0x00000000, 0x00000000, 0x00000000, 0x3f803f80, 0x00000000, 0x00000000, 0x00000000
.long 0x3f803f80, 0x00000000, 0x00003f80, 0x00000000, 0x3f800000, 0x00000000, 0x3f803f80, 0x00000000
.long 0x00000000, 0x00000000, 0x3f803f80, 0x00000000, 0x00000000, 0x00000000, 0x3f800000, 0x00000000
.long 0x00000000, 0x00000000, 0x00000000, 0x00000000, 0x00000000, 0x00000000, 0x00000000, 0x00000000
.long 0x00000000, 0x00000000, 0x00000000, 0x00000000, 0x00000000, 0x00000000, 0x00000000, 0x00000000
.long 0x00000000, 0x00000000, 0x00000000, 0x00000000, 0x00000000, 0x00000000, 0x00000000, 0x00000000
.long 0x00000000, 0x00003f80, 0x00000000, 0x00000000, 0x00000000, 0x3f803f80, 0x00000000, 0x00000000
.long 0x00000000, 0x3f803f80, 0x00000000, 0x00003f80, 0x00000000, 0x3f800000, 0x00000000, 0x3f803f80
.long 0x00000000, 0x00000000, 0x00000000, 0x3f803f80, 0x00000000, 0x00000000, 0x00000000, 0x3f800000
.long 0x00000000, 0x00000000, 0x00000000, 0x00000000, 0x00000000, 0x00000000, 0x00000000, 0x00000000
.long 0x00003f80, 0x00000000, 0x00000000, 0x00000000, 0x3f803f80, 0x00000000, 0x00000000, 0x00000000
.long 0x3f803f80, 0x00000000, 0x00003f80, 0x00000000, 0x3f800000, 0x00000000, 0x3f803f80, 0x00000000
.long 0x00000000, 0x00000000, 0x3f803f80, 0x00000000, 0x00000000, 0x00000000, 0x3f800000, 0x00000000
.long 0x00000000, 0x00000000, 0x00000000, 0x00000000, 0x00000000, 0x00000000, 0x00000000, 0x00000000
.long 0x00000000, 0x00000000, 0x00000000, 0x00000000, 0x00000000, 0x00000000, 0x00000000, 0x00000000
.long 0x00000000, 0x00000000, 0x00000000, 0x00000000, 0x00000000, 0x00000000, 0x00000000, 0x00000000
.long 0x00000000, 0x00000000, 0x00000000, 0x00000000, 0x00000000, 0x00000000, 0x00000000, 0x00000000
.long 0x00000000, 0x00000000, 0x00000000, 0x00000000, 0x00000000, 0x00000000, 0x00000000, 0x00000000
.long 0x00000000, 0x00000000, 0x00000000, 0x00000000, 0x00000000, 0x00000000, 0x00000000, 0x00000000
.long 0x00000000, 0x00000000, 0x00000000, 0x00000000, 0x00000000, 0x00000000, 0x00000000, 0x00000000
.long 0x00000000, 0x00003f80, 0x00000000, 0x00000000, 0x00000000, 0x3f803f80, 0x00000000, 0x00000000
.long 0x00000000, 0x00000000, 0x00000000, 0x00000000, 0x00000000, 0x00000000, 0x00000000, 0x00000000
.long 0x00000000, 0x00000000, 0x00000000, 0x00000000, 0x00000000, 0x00000000, 0x00000000, 0x00000000
.long 0x00000000, 0x00000000, 0x00000000, 0x00000000, 0x00000000, 0x00000000, 0x00000000, 0x00000000
.long 0x00000000, 0x00000000, 0x00000000, 0x00000000, 0x00000000, 0x00000000, 0x00000000, 0x00000000
.long 0x00000000, 0x00000000, 0x00000000, 0x00000000, 0x00000000, 0x00000000, 0x00000000, 0x00000000
.long 0x00000000, 0x00000000, 0x00000000, 0x00000000, 0x00000000, 0x00000000, 0x00000000, 0x00000000
.long 0x00000000, 0x00000000, 0x00000000, 0x00000000, 0x00000000, 0x00000000, 0x00000000, 0x00000000
.long 0x00000000, 0x00000000, 0x00000000, 0x00000000, 0x00000000, 0x00000000, 0x00000000, 0x00000000
.long 0x00000000, 0x00000000, 0x3f803f80, 0x00000000, 0x00000000, 0x00000000, 0x3f800000, 0x00000000
.long 0x00000000, 0x00000000, 0x00000000, 0x00000000, 0x00000000, 0x00000000, 0x00000000, 0x00000000
.long 0x00000000, 0x00000000, 0x00000000, 0x00000000, 0x00000000, 0x00000000, 0x00000000, 0x00000000
.long 0x00000000, 0x00000000, 0x00000000, 0x00000000, 0x00000000, 0x00000000, 0x00000000, 0x00000000
.long 0x00000000, 0x00000000, 0x00000000, 0x00000000, 0x00000000, 0x00000000, 0x00000000, 0x00000000
.long 0x00000000, 0x00000000, 0x00000000, 0x00000000, 0x00000000, 0x00000000, 0x00000000, 0x00000000
.long 0x00000000, 0x00000000, 0x00000000, 0x00000000, 0x00000000, 0x00000000, 0x00000000, 0x00000000
.long 0x00000000, 0x00000000, 0x00000000, 0x00000000, 0x00000000, 0x00000000, 0x00000000, 0x00000000
.long 0x3f803f80, 0x00000000, 0x3f803f80, 0x00000000, 0x3f803f80, 0x00000000, 0x3f803f80, 0x00000000
.long 0x3f803f80, 0x00000000, 0x3f803f80, 0x00000000, 0x3f800000, 0x00000000, 0x3f803f80, 0x00000000
.long 0x00000000, 0x00000000, 0x3f803f80, 0x00000000, 0x00000000, 0x00000000, 0x3f800000, 0x00000000
.long 0x00000000, 0x00000000, 0x00000000, 0x00000000, 0x00000000, 0x00000000, 0x00000000, 0x00000000
.long 0x00000000, 0x00000000, 0x00000000, 0x00000000, 0x00000000, 0x00000000, 0x00000000, 0x00000000
.long 0x00000000, 0x00000000, 0x00000000, 0x00000000, 0x00000000, 0x00000000, 0x00000000, 0x00000000
.long 0x00000000, 0x00000000, 0x00000000, 0x00000000, 0x00000000, 0x00000000, 0x00000000, 0x00000000
.long 0x00000000, 0x00000000, 0x00000000, 0x00000000, 0x00000000, 0x00000000, 0x00000000, 0x00000000
.long 0x00000000, 0x00003f80, 0x00000000, 0x00000000, 0x00000000, 0x3f803f80, 0x00000000, 0x00000000
.long 0x00000000, 0x3f803f80, 0x00000000, 0x00003f80, 0x00000000, 0x3f803f80, 0x00000000, 0x3f803f80
.long 0x00000000, 0x3f803f80, 0x00000000, 0x3f803f80, 0x00000000, 0x3f803f80, 0x00000000, 0x3f803f80
.long 0x00000000, 0x3f803f80, 0x00000000, 0x3f803f80, 0x00000000, 0x3f800000, 0x00000000, 0x3f803f80
.long 0x00003f80, 0x00000000, 0x00000000, 0x3f803f80, 0x3f803f80, 0x00000000, 0x00000000, 0x3f800000
.long 0x3f803f80, 0x00000000, 0x00003f80, 0x00000000, 0x3f803f80, 0x00000000, 0x3f803f80, 0x00000000
.long 0x3f803f80, 0x00000000, 0x3f803f80, 0x00000000, 0x3f803f80, 0x00000000, 0x3f803f80, 0x00000000
.long 0x3f803f80, 0x00000000, 0x3f803f80, 0x00000000, 0x3f800000, 0x00000000, 0x3f803f80, 0x00000000
.long 0x00000000, 0x00000000, 0x00000000, 0x00000000, 0x00000000, 0x00000000, 0x00000000, 0x00000000
.long 0x00000000, 0x00000000, 0x00000000, 0x00000000, 0x00000000, 0x00000000, 0x00000000, 0x00000000
.long 0x00000000, 0x00003f80, 0x00000000, 0x00000000, 0x00000000, 0x3f803f80, 0x00000000, 0x00000000
.long 0x00000000, 0x3f803f80, 0x00000000, 0x00003f80, 0x00000000, 0x3f803f80, 0x00000000, 0x3f803f80
.long 0x00000000, 0x3f803f80, 0x00000000, 0x3f803f80, 0x00000000, 0x3f803f80, 0x00000000, 0x3f803f80
.long 0x00000000, 0x3f803f80, 0x00000000, 0x3f803f80, 0x00000000, 0x3f800000, 0x00000000, 0x3f803f80
.long 0x00003f80, 0x00000000, 0x00000000, 0x3f803f80, 0x3f803f80, 0x00000000, 0x00000000, 0x3f800000
.long 0x3f803f80, 0x00000000, 0x00003f80, 0x00000000, 0x3f803f80, 0x00000000, 0x3f803f80, 0x00000000
.long 0x3f803f80, 0x3f800000, 0x00000000, 0x3f803f80, 0x3f803f80, 0x00000000, 0x00003f80, 0x3f803f80
.long 0x3f803f80, 0x00000000, 0x3f803f80, 0x3f800000, 0x3f803f80, 0x00000000, 0x3f803f80, 0x00000000
.long 0x3f803f80, 0x00000000, 0x3f803f80, 0x00000000, 0x3f803f80, 0x00000000, 0x3f803f80, 0x00000000
.long 0x3f803f80, 0x00000000, 0x3f803f80, 0x00000000, 0x3f803f80, 0x00000000, 0x3f803f80, 0x00000000
.long 0x3f800000, 0x00000000, 0x3f803f80, 0x00000000, 0x00000000, 0x00000000, 0x3f803f80, 0x00000000
.long 0x00000000, 0x00000000, 0x3f800000, 0x00000000, 0x00000000, 0x00000000, 0x00000000, 0x00000000
.long 0x00000000, 0x00000000, 0x00000000, 0x00000000, 0x00000000, 0x00000000, 0x00000000, 0x00000000
.long 0x00000000, 0x00000000, 0x00000000, 0x00000000, 0x00000000, 0x00000000, 0x00000000, 0x00000000
.long 0x00000000, 0x3f803f80, 0x00000000, 0x3f803f80, 0x00000000, 0x3f803f80, 0x00000000, 0x3f803f80
.long 0x00000000, 0x3f803f80, 0x00000000, 0x3f803f80, 0x00003f80, 0x3f803f80, 0x00000000, 0x3f803f80
.long 0x3f803f80, 0x3f800000, 0x00000000, 0x3f803f80, 0x3f803f80, 0x00000000, 0x00003f80, 0x3f803f80
.long 0x3f803f80, 0x00000000, 0x3f803f80, 0x3f800000, 0x3f803f80, 0x00000000, 0x3f803f80, 0x00000000
.long 0x3f803f80, 0x00000000, 0x3f803f80, 0x00000000, 0x3f803f80, 0x00000000, 0x3f803f80, 0x00000000
.long 0x3f803f80, 0x00000000, 0x3f803f80, 0x00000000, 0x3f803f80, 0x00000000, 0x3f803f80, 0x00000000
.long 0x3f800000, 0x00000000, 0x3f803f80, 0x00000000, 0x00000000, 0x00000000, 0x3f803f80, 0x00000000
.long 0x00000000, 0x00000000, 0x3f800000, 0x00000000, 0x00000000, 0x00000000, 0x00000000, 0x00000000
.long 0x00000000, 0x00000000, 0x00000000, 0x00000000, 0x00000000, 0x00000000, 0x00000000, 0x00000000
.long 0x00000000, 0x00000000, 0x00000000, 0x00000000, 0x00000000, 0x00000000, 0x00000000, 0x00000000
.long 0x00000000, 0x00000000, 0x00000000, 0x00000000, 0x00000000, 0x00000000, 0x00000000, 0x00000000
.long 0x00000000, 0x00000000, 0x00000000, 0x00000000, 0x00000000, 0x00003f80, 0x00000000, 0x00000000
.long 0x00000000, 0x3f803f80, 0x00000000, 0x00000000, 0x00000000, 0x3f803f80, 0x00000000, 0x00003f80
.long 0x00000000, 0x3f803f80, 0x00000000, 0x3f803f80, 0x00000000, 0x3f803f80, 0x00000000, 0x3f803f80
.long 0x00000000, 0x3f803f80, 0x00000000, 0x3f803f80, 0x00000000, 0x3f803f80, 0x00000000, 0x3f803f80
.long 0x00000000, 0x3f803f80, 0x00000000, 0x3f803f80, 0x00003f80, 0x3f803f80, 0x00000000, 0x3f803f80
.long 0x00000000, 0x00000000, 0x00000000, 0x00000000, 0x00000000, 0x00000000, 0x00000000, 0x00000000
.long 0x00000000, 0x00000000, 0x00000000, 0x00000000, 0x00000000, 0x00000000, 0x00000000, 0x00000000
.long 0x00000000, 0x00000000, 0x00000000, 0x00000000, 0x00000000, 0x00000000, 0x00000000, 0x00000000
.long 0x00000000, 0x00000000, 0x00000000, 0x00000000, 0x00000000, 0x00000000, 0x00000000, 0x00000000
.long 0x00000000, 0x00000000, 0x00000000, 0x00000000, 0x00000000, 0x00000000, 0x00000000, 0x00000000
.long 0x00000000, 0x00000000, 0x00000000, 0x00000000, 0x00000000, 0x00003f80, 0x00000000, 0x00000000
.long 0x00000000, 0x3f803f80, 0x00000000, 0x00000000, 0x00000000, 0x3f803f80, 0x00000000, 0x00003f80
.long 0x00000000, 0x3f803f80, 0x00000000, 0x3f803f80, 0x00000000, 0x3f803f80, 0x00000000, 0x3f803f80
.long 0x00000000, 0x00000000, 0x00000000, 0x00000000, 0x00000000, 0x00000000, 0x00000000, 0x00000000
.long 0x00000000, 0x00000000, 0x00000000, 0x00000000, 0x00000000, 0x00000000, 0x00000000, 0x00000000
.long 0x00000000, 0x00000000, 0x00000000, 0x00000000, 0x00000000, 0x00000000, 0x00000000, 0x00000000
.long 0x00000000, 0x00000000, 0x00000000, 0x00000000, 0x00000000, 0x00000000, 0x00000000, 0x00000000
.long 0x00000000, 0x00000000, 0x00000000, 0x00000000, 0x00000000, 0x00000000, 0x00000000, 0x00000000
.long 0x00000000, 0x00000000, 0x00000000, 0x00000000, 0x00000000, 0x00000000, 0x00000000, 0x00000000
.long 0x00000000, 0x00000000, 0x00000000, 0x00000000, 0x00000000, 0x00000000, 0x00000000, 0x00000000
.long 0x00000000, 0x00000000, 0x00000000, 0x00000000, 0x00000000, 0x00000000, 0x00000000, 0x00000000
.long 0x00000000, 0x00000000, 0x00000000, 0x00000000, 0x00000000, 0x00000000, 0x00000000, 0x00000000
.long 0x00000000, 0x00000000, 0x00000000, 0x00000000, 0x00000000, 0x00000000, 0x00000000, 0x00000000
.long 0x00000000, 0x00000000, 0x00000000, 0x00000000, 0x00000000, 0x00000000, 0x00000000, 0x00000000
.long 0x00000000, 0x00000000, 0x00000000, 0x00000000, 0x00000000, 0x00000000, 0x00000000, 0x00000000
.long 0x00000000, 0x00000000, 0x00000000, 0x00000000, 0x00000000, 0x00000000, 0x00000000, 0x00000000
.long 0x00000000, 0x00000000, 0x00000000, 0x00000000, 0x00000000, 0x00000000, 0x00000000, 0x00000000
.long 0x00000000, 0x00000000, 0x00000000, 0x00000000, 0x00000000, 0x00000000, 0x00000000, 0x00000000
.long 0x00000000, 0x00000000, 0x00000000, 0x00000000, 0x00000000, 0x00000000, 0x00000000, 0x00000000
.long 0x00000000, 0x00000001, 0x00000000, 0x00000000, 0x00000000, 0x00010000, 0x00000000, 0x00000000
.long 0x00000000, 0x00000000, 0x00000000, 0x00000001, 0x00000000, 0x00000000, 0x00000000, 0x00010000
.long 0x00000000, 0x00000000, 0x00000000, 0x00000000, 0x00000000, 0x00000000, 0x00000000, 0x00000000
.long 0x00000000, 0x00000000, 0x00000000, 0x00000000, 0x00000000, 0x00000000, 0x00000000, 0x00000000
.long 0x00000001, 0x00000000, 0x00000000, 0x00000000, 0x00010000, 0x00000000, 0x00000000, 0x00000000
.long 0x00000000, 0x00000000, 0x00000001, 0x00000000, 0x00000000, 0x00000000, 0x00010000, 0x00000000
.long 0x00000000, 0x00000000, 0x00000000, 0x00000000, 0x00000000, 0x00000000, 0x00000000, 0x00000000
.long 0x00000000, 0x00000000, 0x00000000, 0x00000000, 0x00000000, 0x00000000, 0x00000000, 0x00000000
.long 0x00000000, 0x00000000, 0x00000000, 0x00000000, 0x00000000, 0x00000000, 0x00000000, 0x00000000
.long 0x00000000, 0x00000000, 0x00000000, 0x00000000, 0x00000000, 0x00000000, 0x00000000, 0x00000000
.long 0x00000000, 0x00000001, 0x00000000, 0x00000000, 0x00000000, 0x00010000, 0x00000000, 0x00000000
.long 0x00000000, 0x00000000, 0x00000000, 0x00000001, 0x00000000, 0x00000000, 0x00000000, 0x00010000
.long 0x00000000, 0x00000000, 0x00000000, 0x00000000, 0x00000000, 0x00000000, 0x00000000, 0x00000000
.long 0x00000000, 0x00000000, 0x00000000, 0x00000000, 0x00000000, 0x00000000, 0x00000000, 0x00000000
.long 0x00000001, 0x00000000, 0x00000000, 0x00000000, 0x00010000, 0x00000000, 0x00000000, 0x00000000
.long 0x00000000, 0x00000000, 0x00000001, 0x00000000, 0x00000000, 0x00000000, 0x00010000, 0x00000000
.long 0x31f031f0, 0x10240000, 0x0ff00000, 0x39c00dd0, 0x27502750, 0x10260110, 0x11000020, 0x3b400ee0
.long 0x36303630, 0x102c0220, 0x09900040, 0x39d00ff0, 0x37403740, 0x102e0330, 0x0aa00060, 0x3b501100
.long 0x2ec02ec0, 0x10340440, 0x03300080, 0x39e00990, 0x2ec02ec0, 0x10360550, 0x044000a0, 0x3b600aa0
.long 0x30e030e0, 0x103c0660, 0x055000c0, 0x39f00330, 0x2db02db0, 0x103e0770, 0x066000e0, 0x3b700440
.long 0x25302530, 0x10200880, 0x07700100, 0x3a000550, 0x26402640, 0x10220990, 0x08800120, 0x3b800660
.long 0x2b902b90, 0x10280aa0, 0x01100140, 0x3a100770, 0x2a802a80, 0x102a0bb0, 0x02200160, 0x3b900880
.long 0x2db02db0, 0x10300cc0, 0x0bb80180, 0x3a200110, 0x2db02db0, 0x10320dd0, 0x0cc801a0, 0x3ba00220
.long 0x29702970, 0x10380ee0, 0x0dd801c0, 0x3a300bb8, 0x24202420, 0x103a0ff0, 0x0ee801e0, 0x3bb00cc8
.long 0x38503850, 0x00041100, 0x0bb00010, 0x39a00108, 0x2fd02fd0, 0x00061210, 0x0cc00030, 0x3b200218
.long 0x35203520, 0x000c1320, 0x0dd00050, 0x39b00bb0, 0x23102310, 0x000e1430, 0x0ee00070, 0x3b300cc0
.long 0x24202420, 0x00141540, 0x0ff00090, 0x39c00dd0, 0x2ca02ca0, 0x00161650, 0x110000b0, 0x3b400ee0
.long 0x28602860, 0x001c1760, 0x099000d0, 0x39d00ff0, 0x22003980, 0x001e1870, 0x0aa000f0, 0x3b501100
.long 0x34103980, 0x00001980, 0x03300110, 0x39e00990, 0x39803980, 0x00021a90, 0x04400130, 0x3b600aa0
.long 0x39803980, 0x00081ba0, 0x05500150, 0x39f00330, 0x39803980, 0x000a1cb0, 0x06600170, 0x3b700440
.long 0x33003960, 0x00101dc0, 0x07700190, 0x3a000550, 0x39603960, 0x00121ed0, 0x088001b0, 0x3b800660
.long 0x39603960, 0x00181fe0, 0x011001d0, 0x3a100770, 0x39603960, 0x001a20f0, 0x022001f0, 0x3b900880
.long 0x32003200, 0x00040010, 0x0fe80020, 0x39800dc8, 0x27602760, 0x00060120, 0x10f80040, 0x3b000ed8
.long 0x36403640, 0x000c0230, 0x09880060, 0x39900fe8, 0x37503750, 0x000e0340, 0x0a980080, 0x3b1010f8
.long 0x2ed02ed0, 0x00140450, 0x032800a0, 0x39a00988, 0x2ed02ed0, 0x00160560, 0x043800c0, 0x3b200a98
.long 0x30f030f0, 0x001c0670, 0x054800e0, 0x39b00328, 0x2dc02dc0, 0x001e0780, 0x06580100, 0x3b300438
.long 0x25402540, 0x00000890, 0x07680120, 0x39c00548, 0x26502650, 0x000209a0, 0x08780140, 0x3b400658
.long 0x2ba02ba0, 0x00080ab0, 0x01080160, 0x39d00768, 0x2a902a90, 0x000a0bc0, 0x02180180, 0x3b500878
.long 0x2dc02dc0, 0x00100cd0, 0x0bb001a0, 0x39e00108, 0x2dc02dc0, 0x00120de0, 0x0cc001c0, 0x3b600218
.long 0x29802980, 0x00180ef0, 0x0dd001e0, 0x39f00bb0, 0x24302430, 0x001a1000, 0x0ee00200, 0x3b700cc0
.long 0x38603860, 0x00041110, 0x0ba80030, 0x39600100, 0x2fe02fe0, 0x00061220, 0x0cb80050, 0x3ae00210
.long 0x35303530, 0x000c1330, 0x0dc80070, 0x39700ba8, 0x23202320, 0x000e1440, 0x0ed80090, 0x3af00cb8
.long 0x24302430, 0x00141550, 0x0fe800b0, 0x39800dc8, 0x2cb02cb0, 0x00161660, 0x10f800d0, 0x3b000ed8
.long 0x28702870, 0x001c1770, 0x098800f0, 0x39900fe8, 0x22103990, 0x001e1880, 0x0a980110, 0x3b1010f8
.long 0x34203990, 0x00001990, 0x03280130, 0x39a00988, 0x39903990, 0x00021aa0, 0x04380150, 0x3b200a98
.long 0x39903990, 0x00081bb0, 0x05480170, 0x39b00328, 0x39903990, 0x000a1cc0, 0x06580190, 0x3b300438
.long 0x33103970, 0x00101dd0, 0x076801b0, 0x39c00548, 0x39703970, 0x00121ee0, 0x087801d0, 0x3b400658
.long 0x39703970, 0x00181ff0, 0x010801f0, 0x39d00768, 0x39703970, 0x001a2100, 0x02180210, 0x3b500878
.long 0x02103cc4, 0x00003cd0, 0x00001320, 0x0c0c0c0c, 0x02143cc8, 0x00013cd2, 0x00001328, 0x0c0c0c0c
.long 0x02183ccc, 0x00103cd4, 0x00001330, 0x0c0c0c0c, 0x021c3cd0, 0x00113cd6, 0x00001338, 0x0c0c0100
.long 0x03203cd4, 0x00203cd8, 0x000052e0, 0x0c0c0c0c, 0x03243cd8, 0x00213cda, 0x000052e8, 0x0c0c0c0c
.long 0x03283cdc, 0x00303cdc, 0x000052f0, 0x0c0c0c0c, 0x032c3ce0, 0x00313cde, 0x000052f8, 0x0c0c0c0c
.long 0x04303ce4, 0x00403ce0, 0x000092a0, 0x05040504, 0x04343ce8, 0x00413ce2, 0x000092a8, 0x0c0c0c0c
.long 0x04383cec, 0x00503ce4, 0x000092b0, 0x0c0c0c0c, 0x043c3cf0, 0x00513ce6, 0x000092b8, 0x0c0c0c0c
.long 0x05403cf4, 0x00603ce8, 0x0000d260, 0x05040504, 0x05443cf8, 0x00613cea, 0x0000d268, 0x0c0c0c0c
.long 0x05483cfc, 0x00703cec, 0x0000d270, 0x0c0c0c0c, 0x054c3d00, 0x00713cee, 0x0000d278, 0x0c0c0c0c
.long 0x06503cb4, 0x00803cf0, 0x00001340, 0x05040302, 0x06543cb8, 0x00813cf2, 0x00001348, 0x0c0c0c0c
.long 0x06583cbc, 0x00903cf4, 0x00001350, 0x0c0c0c0c, 0x065c3cc0, 0x00913cf6, 0x00001358, 0x0c0c0c0c
.long 0x07603cc4, 0x00a03cf8, 0x00005300, 0x03020302, 0x07643cc8, 0x00a13cfa, 0x00005308, 0x0c0c0c0c
.long 0x07683ccc, 0x00b03cfc, 0x00005310, 0x0c0c0c0c, 0x076c3cd0, 0x00b13cfe, 0x00005318, 0x0c0c0c0c
.long 0x08703cd4, 0x00c03d00, 0x000092c0, 0x03020302, 0x08743cd8, 0x00c13d02, 0x000092c8, 0x0c0c0c0c
.long 0x08783cdc, 0x00d03d04, 0x000092d0, 0x0c0c0c0c, 0x087c3ce0, 0x00d13d06, 0x000092d8, 0x0c0c0c0c
.long 0x09803ce4, 0x00e03d08, 0x0000d280, 0x03020c0c, 0x09843ce8, 0x00e13d0a, 0x0000d288, 0x0c0c0c0c
.long 0x09883cec, 0x00f03d0c, 0x0000d290, 0x0c0c0c0c, 0x098c3cf0, 0x00f13d0e, 0x0000d298, 0x0c0c0c0c
.long 0x09903ca4, 0x00003d50, 0x00001320, 0x0c0c0c0c, 0x0a943ca8, 0x00013d52, 0x00001328, 0x0c0c0c0c
.long 0x0a983cac, 0x00103d54, 0x00001330, 0x0c0c0c0c, 0x0a9c3cb0, 0x00113d56, 0x00001338, 0x0c0c0c0c
.long 0x0aa03cb4, 0x00203d58, 0x000052e0, 0x0c0c0100, 0x0ba43cb8, 0x00213d5a, 0x000052e8, 0x0c0c0c0c
.long 0x0ba83cbc, 0x00303d5c, 0x000052f0, 0x0c0c0c0c, 0x0bac3cc0, 0x00313d5e, 0x000052f8, 0x0c0c0c0c
.long 0x0bb03cc4, 0x00403d60, 0x000092a0, 0x0c0c0c0c, 0x0cb43cc8, 0x00413d62, 0x000092a8, 0x05040504
.long 0x0cb83ccc, 0x00503d64, 0x000092b0, 0x0c0c0c0c, 0x0cbc3cd0, 0x00513d66, 0x000092b8, 0x0c0c0c0c
.long 0x0cc03cd4, 0x00603d68, 0x0000d260, 0x0c0c0c0c, 0x0dc43cd8, 0x00613d6a, 0x0000d268, 0x05040504
.long 0x0dc83cdc, 0x00703d6c, 0x0000d270, 0x0c0c0c0c, 0x0dcc3ce0, 0x00713d6e, 0x0000d278, 0x0c0c0c0c
.long 0x0dd03c94, 0x00803d70, 0x00001340, 0x0c0c0c0c, 0x0ed43c98, 0x00813d72, 0x00001348, 0x05040302
.long 0x0ed83c9c, 0x00903d74, 0x00001350, 0x0c0c0c0c, 0x0edc3ca0, 0x00913d76, 0x00001358, 0x0c0c0c0c
.long 0x0ee03ca4, 0x00a03d78, 0x00005300, 0x0c0c0c0c, 0x0fe43ca8, 0x00a13d7a, 0x00005308, 0x03020302
.long 0x0fe83cac, 0x00b03d7c, 0x00005310, 0x0c0c0c0c, 0x0fec3cb0, 0x00b13d7e, 0x00005318, 0x0c0c0c0c
.long 0x0ff03cb4, 0x00c03d80, 0x000092c0, 0x0c0c0c0c, 0x10f43cb8, 0x00c13d82, 0x000092c8, 0x03020302
.long 0x10f83cbc, 0x00d03d84, 0x000092d0, 0x0c0c0c0c, 0x10fc3cc0, 0x00d13d86, 0x000092d8, 0x0c0c0c0c
.long 0x11003cc4, 0x00e03d88, 0x0000d280, 0x0c0c0c0c, 0x12043cc8, 0x00e13d8a, 0x0000d288, 0x03020c0c
.long 0x12043ccc, 0x00f03d8c, 0x0000d290, 0x03020c0c, 0x12043cd0, 0x00f13d8e, 0x0000d298, 0x03020c0c
.section .rodata,"a"
.p2align 6
.amdhsa_kernel standalone__ssm_conv_s4__prompt_kernel
  .amdhsa_next_free_vgpr 256
  .amdhsa_next_free_sgpr 102
  .amdhsa_accum_offset 256
  .amdhsa_group_segment_fixed_size 0
  .amdhsa_kernarg_size 96
  .amdhsa_user_sgpr_count 2
  .amdhsa_user_sgpr_kernarg_segment_ptr 1
  .amdhsa_system_sgpr_workgroup_id_x 1
  .amdhsa_ieee_mode 0
.end_amdhsa_kernel
```
